```python
import torch

def _softmax(x, axis=-1):
    return torch.softmax(x, dim=axis)
def _gelu(x):
    return torch.nn.functional.gelu(x, approximate="tanh")
def _silu(x):
    return torch.nn.functional.silu(x)
def _sigmoid(x):
    return torch.sigmoid(x)
def _layernorm(x, axis=-1, eps=1e-5):
    m = x.mean(dim=axis, keepdim=True)
    v = x.var(dim=axis, keepdim=True, unbiased=False)
    return (x - m) / torch.sqrt(v + eps)
def _scatter_add(tgt, idx, src, axis=0):
    return tgt.clone().index_add_(axis, idx, src)
def _segment_sum(src, seg, n):
    out = torch.zeros((n,) + src.shape[1:], dtype=src.dtype)
    return out.index_add_(0, seg, src)
def _pad(x, pw):
    flat = tuple(v for pair in reversed(pw) for v in pair)
    return torch.nn.functional.pad(x, flat)

kernel_name = 'concat_heads__grouped_kv_mqa__ssm_conv_s5__prompt'

def setup_inputs():

    _w = (lambda a: (lambda t: t.to(torch.bfloat16) if t.is_floating_point() else t)(torch.as_tensor(a)))
    def _A_setup():
        B, S, D, H = 1, 2048, 512, 32
        Dh = D // H
        return {
            "x": _w((lambda *s: torch.randn(*s, dtype=torch.bfloat16) * 0.05)(B, S, D)),
            "wq": _w((lambda *s: torch.randn(*s, dtype=torch.bfloat16) * 0.8)(D, H * Dh)),
            "wk": _w((lambda *s: torch.randn(*s, dtype=torch.bfloat16) * 0.8)(D, Dh)),
            "wv": _w((lambda *s: torch.randn(*s, dtype=torch.bfloat16) * 0.05)(D, Dh)),
            "wo": _w((lambda *s: torch.randn(*s, dtype=torch.bfloat16) * 0.05)(H * Dh, D)),
        }
    _A_in = _A_setup()

    def _B_setup():
        B, S, D = 1, 2048, 512
        P = D
        Lambda_re = -0.5 * (lambda _x: torch.exp(torch.as_tensor(_x)))((lambda *s: torch.randn(*s, dtype=torch.bfloat16) * 0.2)(P))
        Lambda_im = (lambda *s: torch.randn(*s, dtype=torch.bfloat16) * 0.4)(P) * 1.0
        B_re = (lambda *s: torch.randn(*s, dtype=torch.bfloat16) * 0.2)(P, D) * (D ** -0.5)
        B_im = (lambda *s: torch.randn(*s, dtype=torch.bfloat16) * 0.2)(P, D) * (D ** -0.5)
        C_re = (lambda *s: torch.randn(*s, dtype=torch.bfloat16) * 0.2)(D, P) * (P ** -0.5)
        C_im = (lambda *s: torch.randn(*s, dtype=torch.bfloat16) * 0.2)(D, P) * (P ** -0.5)
        log_dt = (lambda *s: torch.randn(*s, dtype=torch.bfloat16) * 0.2)(P) * 0.3 - 2.0
        Dskip = (lambda *s: torch.randn(*s, dtype=torch.bfloat16) * 0.05)(D)
        return {
            "x": _w((lambda *s: torch.randn(*s, dtype=torch.bfloat16) * 0.05)(B, S, D)),
            "Lambda_re": _w(Lambda_re),
            "Lambda_im": _w(Lambda_im),
            "B_re": _w(B_re),
            "B_im": _w(B_im),
            "C_re": _w(C_re),
            "C_im": _w(C_im),
            "log_dt": _w(log_dt),
            "Dskip": _w(Dskip),
        }
    _B_in = _B_setup()

    return {
        "A_x": _A_in["x"],
        "A_wq": _A_in["wq"],
        "A_wk": _A_in["wk"],
        "A_wv": _A_in["wv"],
        "A_wo": _A_in["wo"],
        "B_x": _B_in["x"],
        "B_Lambda_re": _B_in["Lambda_re"],
        "B_Lambda_im": _B_in["Lambda_im"],
        "B_B_re": _B_in["B_re"],
        "B_B_im": _B_in["B_im"],
        "B_C_re": _B_in["C_re"],
        "B_C_im": _B_in["C_im"],
        "B_log_dt": _B_in["log_dt"],
        "B_Dskip": _B_in["Dskip"],
    }

def reference(A_x, A_wq, A_wk, A_wv, A_wo, B_x, B_Lambda_re, B_Lambda_im, B_B_re, B_B_im, B_C_re, B_C_im, B_log_dt, B_Dskip):
    def _A_ref(x, wq, wk, wv, wo):
        B, S, D = x.shape
        H = 32
        Dh = D // H
        q = (lambda x, *d: x.permute(*d))((x @ wq).reshape(B, S, H, Dh), 0, 2, 1, 3)
        k = x @ wk
        v = x @ wv
        scores = torch.einsum("bhqd,bkd->bhqk", q, k) * (Dh ** -0.5)
        p = _softmax(scores, axis=-1)
        o = torch.einsum("bhqk,bkd->bhqd", p, v)
        return (lambda x, *d: x.permute(*d))(o, 0, 2, 1, 3).reshape(B, S, H * Dh) @ wo

    def _B_ref(x, Lambda_re, Lambda_im, B_re, B_im, C_re, C_im, log_dt, Dskip):
        Bsz, L, H = x.shape
        Lam = Lambda_re + 1j * Lambda_im
        Bmat = B_re + 1j * B_im
        Cmat = C_re + 1j * C_im
        dt = torch.exp(log_dt)
        Lam_bar = torch.exp(dt * Lam)
        B_bar = ((Lam_bar - 1.0) / Lam)[:, None] * Bmat
        Bu = torch.einsum("bld,pd->blp", x + 0j, B_bar)
        h = torch.zeros_like(Bu[:, 0, :])
        hs = []
        for t in range(L):
            h = Lam_bar[None, :] * h + Bu[:, t, :]
            hs.append(h)
        hseq = torch.stack(hs, 1)
        y = 2.0 * torch.einsum("blp,dp->bld", hseq, Cmat).real + x * Dskip[None, None, :]
        return y

    a = _A_ref(A_x, A_wq, A_wk, A_wv, A_wo)
    b = _B_ref(B_x, B_Lambda_re, B_Lambda_im, B_B_re, B_B_im, B_C_re, B_C_im, B_log_dt, B_Dskip)
    return torch.concatenate([a, b], axis=-1)
```

```asm
; @launch grid=(256,1,1) block=(512,1,1) lds=163840
.amdgcn_target "amdgcn-amd-amdhsa--gfx950"
.text
.globl concat_heads__grouped_kv_mqa__ssm_conv_s5__prompt_kernel
.p2align 8
.type concat_heads__grouped_kv_mqa__ssm_conv_s5__prompt_kernel,@function
concat_heads__grouped_kv_mqa__ssm_conv_s5__prompt_kernel:
    s_cmp_ge_u32 s2, 256
    s_cbranch_scc1 L_exit
    s_load_dwordx16 s[16:31], s[0:1], 0
    s_load_dwordx16 s[32:47], s[0:1], 64
    s_load_dwordx2 s[48:49], s[0:1], 128
    v_and_b32 v250, 63, v0
    v_lshrrev_b32 v249, 6, v0
    v_lshlrev_b32 v251, 4, v250
    v_readfirstlane_b32 s3, v249
    s_nop 0
    s_cmp_lg_u32 s3, 5
    s_cbranch_scc1 L_nocpf
    s_getpc_b64 s[76:77]
L_pc:
    s_lshr_b32 s9, s2, 3
    s_mul_i32 s9, s9, 1536
    s_min_u32 s9, s9, L_exit-concat_heads__grouped_kv_mqa__ssm_conv_s5__prompt_kernel-1536
    s_sub_u32 s76, s76, L_pc-concat_heads__grouped_kv_mqa__ssm_conv_s5__prompt_kernel
    s_subb_u32 s77, s77, 0
    v_min_u32 v2, 23, v250
    v_lshlrev_b32 v2, 6, v2
    v_add_u32 v2, s9, v2
    v_mov_b32 v3, s77
    v_add_co_u32 v2, vcc, s76, v2
    s_nop 1
    v_addc_co_u32 v3, vcc, 0, v3, vcc
    s_mov_b64 exec, 0xffffff
    global_load_dword v252, v[2:3], off
    s_mov_b64 exec, -1
L_nocpf:
    s_and_b32 s9, s2, 7
    s_lshr_b32 s10, s2, 3
    s_lshr_b32 s11, s10, 3
    s_lshl2_add_u32 s4, s9, s11
    s_and_b32 s5, s10, 7
    s_lshr_b32 s6, s4, 1
    s_and_b32 s7, s10, 15
    s_and_b32 s72, s3, 3
    s_cmp_ge_u32 s3, 4
    s_cbranch_scc1 L_service
    s_lshr_b32 s14, s5, 1
    s_lshl_b32 s13, s4, 16
    s_lshl2_add_u32 s9, s14, s72
    s_lshl_b32 s9, s9, 2
    s_mul_i32 s10, s9, 1040
    s_add_u32 m0, s10, 29696
    s_lshl_b32 s9, s9, 10
    s_add_u32 s9, s9, s13
    s_waitcnt lgkmcnt(0)
    s_mov_b32 s52, s16
    s_mov_b32 s53, s17
    s_mov_b32 s54, 0x200000
    s_mov_b32 s55, 0x20000
    buffer_load_dwordx4 v251, s[52:55], s9 offen offset:0 lds
    s_add_u32 m0, m0, 16
    s_nop 0
    buffer_load_dwordx4 v251, s[52:55], s9 offen offset:1024 lds
    s_add_u32 m0, m0, 16
    s_nop 0
    buffer_load_dwordx4 v251, s[52:55], s9 offen offset:2048 lds
    s_add_u32 m0, m0, 16
    s_nop 0
    buffer_load_dwordx4 v251, s[52:55], s9 offen offset:3072 lds
    s_bitcmp1_b32 s5, 0
    s_cselect_b32 s56, s22, s20
    s_cselect_b32 s57, s23, s21
    s_mov_b32 s58, 0x4000
    s_mov_b32 s59, 0x20000
    s_lshl_b32 s9, s3, 12
    s_add_u32 m0, s9, 13312
    v_lshrrev_b32 v2, 1, v251
    v_and_b32 v2, 128, v2
    v_xor_b32 v2, v2, v251
    buffer_load_dwordx4 v2, s[56:59], s9 offen offset:0 lds
    buffer_load_dwordx4 v2, s[56:59], s9 offen offset:1024 lds
    buffer_load_dwordx4 v2, s[56:59], s9 offen offset:2048 lds
    buffer_load_dwordx4 v2, s[56:59], s9 offen offset:3072 lds
    s_mov_b32 s60, s18
    s_mov_b32 s61, s19
    s_mov_b32 s62, 0x80000
    s_mov_b32 s63, 0x20000
    v_lshrrev_b32 v1, 2, v250
    v_and_b32 v1, 4, v1
    v_and_b32 v0, 7, v250
    v_xor_b32 v0, v0, v1
    v_lshlrev_b32 v0, 4, v0
    v_lshrrev_b32 v1, 3, v250
    v_lshl_add_u32 v0, v1, 10, v0
    s_lshl_b32 s12, s72, 13
    s_lshl_b32 s10, s5, 7
    s_add_u32 s12, s12, s10
    s_and_b32 s10, s4, 3
    s_lshl_b32 s10, s10, 17
    s_add_u32 s12, s12, s10
    s_lshl_b32 s11, s72, 10
    s_add_u32 s9, s14, 1
    s_and_b32 s9, s9, 3
    s_lshl2_add_u32 s9, s9, s72
    s_lshl_b32 s9, s9, 2
    s_mul_i32 s10, s9, 1040
    s_add_u32 m0, s10, 29696
    s_lshl_b32 s9, s9, 10
    s_add_u32 s9, s9, s13
    buffer_load_dwordx4 v251, s[52:55], s9 offen offset:0 lds
    s_add_u32 m0, m0, 16
    s_nop 0
    buffer_load_dwordx4 v251, s[52:55], s9 offen offset:1024 lds
    s_add_u32 m0, m0, 16
    s_nop 0
    buffer_load_dwordx4 v251, s[52:55], s9 offen offset:2048 lds
    s_add_u32 m0, m0, 16
    s_nop 0
    buffer_load_dwordx4 v251, s[52:55], s9 offen offset:3072 lds
    v_and_b32 v253, 3, v250
    v_lshlrev_b32 v253, 2, v253
    s_lshl_b32 s9, s72, 2
    v_mov_b32 v254, s9
    v_mov_b32 v255, 1
    s_mov_b32 s64, s48
    s_mov_b32 s65, s49
    s_mov_b32 s66, 0x1000000
    s_mov_b32 s67, 0x20000
    s_barrier
    s_waitcnt vmcnt(4)
    ds_write_b32 v254, v255 offset:0
    s_add_u32 s9, s14, 2
    s_and_b32 s9, s9, 3
    s_lshl2_add_u32 s9, s9, s72
    s_lshl_b32 s9, s9, 2
    s_mul_i32 s10, s9, 1040
    s_add_u32 m0, s10, 29696
    s_lshl_b32 s9, s9, 10
    s_add_u32 s9, s9, s13
    buffer_load_dwordx4 v251, s[52:55], s9 offen offset:0 lds
    s_add_u32 m0, m0, 16
    s_nop 0
    buffer_load_dwordx4 v251, s[52:55], s9 offen offset:1024 lds
    s_add_u32 m0, m0, 16
    s_nop 0
    buffer_load_dwordx4 v251, s[52:55], s9 offen offset:2048 lds
    s_add_u32 m0, m0, 16
    s_nop 0
    buffer_load_dwordx4 v251, s[52:55], s9 offen offset:3072 lds
    s_add_u32 s9, s14, 3
    s_and_b32 s9, s9, 3
    s_lshl2_add_u32 s9, s9, s72
    s_lshl_b32 s9, s9, 2
    s_mul_i32 s10, s9, 1040
    s_add_u32 m0, s10, 29696
    s_lshl_b32 s9, s9, 10
    s_add_u32 s9, s9, s13
    buffer_load_dwordx4 v251, s[52:55], s9 offen offset:0 lds
    s_add_u32 m0, m0, 16
    s_nop 0
    buffer_load_dwordx4 v251, s[52:55], s9 offen offset:1024 lds
    s_add_u32 m0, m0, 16
    s_nop 0
    buffer_load_dwordx4 v251, s[52:55], s9 offen offset:2048 lds
    s_add_u32 m0, m0, 16
    s_nop 0
    buffer_load_dwordx4 v251, s[52:55], s9 offen offset:3072 lds
    s_add_u32 m0, s11, 96256
    s_xor_b32 s9, s12, 0x0
    buffer_load_dwordx4 v0, s[60:63], s9 offen lds
    s_add_u32 m0, s11, 100352
    s_xor_b32 s9, s12, 0x8000
    buffer_load_dwordx4 v0, s[60:63], s9 offen lds
    s_add_u32 m0, s11, 104448
    s_xor_b32 s9, s12, 0x10000
    buffer_load_dwordx4 v0, s[60:63], s9 offen lds
    s_add_u32 m0, s11, 108544
    s_xor_b32 s9, s12, 0x18000
    buffer_load_dwordx4 v0, s[60:63], s9 offen lds
    s_waitcnt vmcnt(4)
    ds_write_b32 v254, v255 offset:16
    s_add_u32 m0, s11, 112640
    s_xor_b32 s9, s12, 0x20000
    buffer_load_dwordx4 v0, s[60:63], s9 offen lds
    s_add_u32 m0, s11, 116736
    s_xor_b32 s9, s12, 0x28000
    buffer_load_dwordx4 v0, s[60:63], s9 offen lds
    s_add_u32 m0, s11, 120832
    s_xor_b32 s9, s12, 0x30000
    buffer_load_dwordx4 v0, s[60:63], s9 offen lds
    s_add_u32 m0, s11, 124928
    s_xor_b32 s9, s12, 0x38000
    buffer_load_dwordx4 v0, s[60:63], s9 offen lds
    s_add_u32 m0, s11, 129024
    s_xor_b32 s9, s12, 0x40000
    buffer_load_dwordx4 v0, s[60:63], s9 offen lds
    s_add_u32 m0, s11, 133120
    s_xor_b32 s9, s12, 0x48000
    buffer_load_dwordx4 v0, s[60:63], s9 offen lds
    s_add_u32 m0, s11, 137216
    s_xor_b32 s9, s12, 0x50000
    buffer_load_dwordx4 v0, s[60:63], s9 offen lds
    s_add_u32 m0, s11, 141312
    s_xor_b32 s9, s12, 0x58000
    buffer_load_dwordx4 v0, s[60:63], s9 offen lds
    s_add_u32 m0, s11, 145408
    s_xor_b32 s9, s12, 0x60000
    buffer_load_dwordx4 v0, s[60:63], s9 offen lds
    s_add_u32 m0, s11, 149504
    s_xor_b32 s9, s12, 0x68000
    buffer_load_dwordx4 v0, s[60:63], s9 offen lds
    s_add_u32 m0, s11, 153600
    s_xor_b32 s9, s12, 0x70000
    buffer_load_dwordx4 v0, s[60:63], s9 offen lds
    s_add_u32 m0, s11, 157696
    s_xor_b32 s9, s12, 0x78000
    buffer_load_dwordx4 v0, s[60:63], s9 offen lds
    s_waitcnt vmcnt(8)
    ds_write_b32 v254, v255 offset:32
    s_branch L_attn
L_service:
    v_mov_b32 v0, 0
    v_mov_b32 v1, 0
    v_mov_b32 v2, 0
    v_mov_b32 v3, 0
    s_lshl_b32 s9, s72, 10
    v_add_u32 v249, s9, v251
    ds_write_b128 v249, v[0:3] offset:1024
    v_lshlrev_b32 v249, 3, v250
    ds_write_b64 v249, v[0:1]
    v_and_b32 v242, 31, v250
    v_lshlrev_b32 v244, 1, v242
    v_lshrrev_b32 v243, 5, v250
    s_waitcnt lgkmcnt(0)
    s_setprio 3
    s_mov_b32 s64, s48
    s_mov_b32 s65, s49
    s_mov_b32 s66, 0x1000000
    s_mov_b32 s67, 0x20000
    s_cmp_lg_u32 s72, 0
    s_cbranch_scc1 L_noepl
    buffer_load_dword v252, off, s[64:67], 0 sc1
L_noepl:
    s_lshl_b32 s9, s7, 6
    s_mov_b32 s52, s28
    s_mov_b32 s53, s29
    s_mov_b32 s54, 0x400
    s_mov_b32 s55, 0x20000
    buffer_load_ushort v238, v244, s[52:55], s9 offen
    s_mov_b32 s52, s30
    s_mov_b32 s53, s31
    s_mov_b32 s54, 0x400
    s_mov_b32 s55, 0x20000
    buffer_load_ushort v239, v244, s[52:55], s9 offen
    s_mov_b32 s52, s40
    s_mov_b32 s53, s41
    s_mov_b32 s54, 0x400
    s_mov_b32 s55, 0x20000
    buffer_load_ushort v240, v244, s[52:55], s9 offen
    s_mov_b32 s52, s42
    s_mov_b32 s53, s43
    s_mov_b32 s54, 0x400
    s_mov_b32 s55, 0x20000
    s_lshl_b32 s9, s5, 7
    s_and_b32 s10, s3, 1
    s_lshl_b32 s10, s10, 6
    s_add_u32 s9, s9, s10
    buffer_load_ushort v241, v244, s[52:55], s9 offen
    s_barrier
    v_and_b32 v253, 3, v250
    v_lshlrev_b32 v253, 2, v253
    s_lshl_b32 s9, s72, 2
    v_mov_b32 v254, s9
    v_mov_b32 v255, 1
    v_bfe_u32 v222, v250, 4, 1
    v_lshlrev_b32 v222, 5, v222
    v_and_b32 v244, 3, v250
    v_lshl_add_u32 v222, v244, 3, v222
    v_bfe_u32 v244, v250, 2, 2
    s_and_b32 s9, s72, 1
    v_lshrrev_b32 v245, 1, v244
    v_xor_b32 v245, s9, v245
    v_lshl_add_u32 v245, v245, 6, v222
    v_lshl_add_u32 v245, v244, 7, v245
    v_lshl_add_u32 v222, v244, 6, v222
    v_lshl_add_u32 v222, v243, 9, v222
    v_lshl_add_u32 v245, v243, 10, v245
    v_add_u32 v245, 96256, v245
    v_mul_u32_u24 v228, 1040, v242
    v_lshl_add_u32 v228, v243, 4, v228
    v_add_u32 v228, 29696, v228
    s_lshr_b32 s9, s72, 1
    s_mul_i32 s9, s9, 33280
    v_add_u32 v246, s9, v228
    s_lshl_b32 s9, s72, 11
    v_add_u32 v247, s9, v251
    s_lshl_b32 s73, s6, 2
    s_add_u32 s73, s73, s72
    s_lshl_b32 s73, s73, 15
    s_mul_i32 s74, s72, 16640
    s_add_u32 s74, s74, 96256
    s_lshl_b32 s75, s4, 1
    s_lshr_b32 s9, s72, 1
    s_add_u32 s75, s75, s9
    s_lshl_b32 s80, s5, 1
    s_and_b32 s9, s72, 1
    s_add_u32 s80, s80, s9
    v_lshlrev_b32 v249, 3, v243
    v_xor_b32 v249, v242, v249
    v_lshlrev_b32 v249, 4, v249
    v_lshl_add_u32 v214, v243, 13, v249
    v_lshl_add_u32 v217, v243, 10, v249
    s_and_b32 s50, s7, 14
    s_and_b32 s9, s7, 2
    s_lshl_b32 s9, s9, 3
    s_lshr_b32 s10, s7, 2
    s_lshl_b32 s10, s10, 1
    s_add_u32 s9, s9, s10
    s_lshl_b32 s9, s9, 10
    s_xor_b32 s81, s7, s6
    s_and_b32 s81, s81, 1
    s_lshl_b32 s81, s81, 9
    s_add_u32 s9, s9, s81
    s_add_u32 s51, s73, s9
    v_lshrrev_b32 v244, 1, v242
    v_mul_u32_u24 v244, 1040, v244
    v_lshl_add_u32 v244, v243, 4, v244
    v_and_b32 v249, 1, v242
    v_mul_u32_u24 v218, 640, v249
    v_mul_u32_u24 v219, 384, v249
    v_add_u32 v218, v218, v244
    v_add_u32 v219, v219, v244
    v_add_u32 v215, s74, v218
    v_add_u32 v216, s74, v219
    v_add_u32 v218, 29696, v218
    v_add_u32 v219, 29696, v219
    v_lshlrev_b32 v220, 3, v250
    v_add_u32 v220, s74, v220
    v_lshlrev_b32 v227, 3, v242
    v_add_u32 v227, 96256, v227
    v_lshlrev_b32 v221, 6, v242
    v_lshl_add_u32 v221, v243, 5, v221
    v_add_u32 v221, s74, v221
    v_add_u32 v222, s74, v222
    v_lshlrev_b32 v223, 4, v242
    v_xor_b32 v249, 1, v243
    v_lshl_add_u32 v223, v249, 12, v223
    v_lshlrev_b32 v224, 10, v242
    v_lshl_add_u32 v224, v243, 4, v224
    v_lshlrev_b32 v225, 2, v242
    v_lshl_add_u32 v225, v243, 14, v225
    v_lshrrev_b32 v249, 2, v250
    v_and_b32 v249, 4, v249
    v_and_b32 v226, 7, v250
    v_xor_b32 v226, v226, v249
    v_lshlrev_b32 v226, 4, v226
    v_lshrrev_b32 v249, 3, v250
    v_lshl_add_u32 v226, v249, 10, v226
    s_and_b32 s9, s72, 1
    s_mul_i32 s10, s9, -32768
    s_add_u32 s10, s10, 33280
    v_add_u32 v229, s10, v228
    s_mul_i32 s10, s9, 33792
    v_add_u32 v228, s10, v228
    v_add_u32 v230, 66560, v228
    v_add_u32 v231, 66560, v229
    v_and_b32 v232, 15, v250
    v_lshlrev_b32 v232, 7, v232
    v_lshlrev_b32 v235, 6, v250
    v_add_u32 v233, s74, v251
    s_xor_b32 s9, s72, 1
    s_mul_i32 s9, s9, 16640
    s_add_u32 s9, s9, 96256
    v_add_u32 v237, s9, v251
    s_lshr_b32 s14, s5, 1
    v_and_b32 v249, 15, v250
    s_lshl_b32 s9, s14, 4
    v_add_u32 v179, s9, v249
    v_mul_u32_u24 v176, 1040, v179
    v_lshrrev_b32 v178, 4, v250
    v_lshl_add_u32 v176, v178, 4, v176
    v_add_u32 v176, 29696, v176
    v_lshlrev_b32 v177, 3, v249
    v_lshl_add_u32 v177, v178, 8, v177
    v_and_b32 v181, 1, v178
    v_lshl_add_u32 v177, v181, 7, v177
    v_xor_b32 v181, 128, v177
    v_add_u32 v177, 13312, v177
    v_add_u32 v181, 13312, v181
    s_and_b32 s10, s5, 1
    s_xor_b32 s11, s10, 1
    v_lshrrev_b32 v179, s10, v178
    v_and_b32 v179, 1, v179
    v_lshlrev_b32 v179, 9, v179
    v_lshl_add_u32 v179, v249, 4, v179
    v_lshrrev_b32 v249, s11, v178
    v_and_b32 v249, 1, v249
    v_lshl_add_u32 v179, v249, 3, v179
    s_lshl_b32 s9, s4, 1
    s_lshr_b32 s11, s14, 1
    s_add_u32 s9, s9, s11
    s_lshl_b32 s9, s9, 1
    s_add_u32 s9, s9, s10
    s_lshl_b32 s9, s9, 10
    s_and_b32 s11, s14, 1
    s_lshl_b32 s11, s11, 8
    s_add_u32 s9, s9, s11
    s_add_u32 s12, s9, 0x10000
    s_lshl_b32 s13, s4, 3
    s_add_u32 s13, s13, s5
    s_lshl_b32 s13, s13, 6
    s_add_u32 s13, s13, 0x8000
    v_mov_b32 v180, 0
    s_lshl_b32 s9, s72, 8
    v_add_u32 v176, s9, v176
    s_lshl_b32 s9, s72, 12
    v_add_u32 v177, s9, v177
    v_add_u32 v181, s9, v181
    s_lshl_b32 s9, s72, 10
    v_add_u32 v178, s9, v251
    s_mov_b32 s15, 400000
W_1:
    ds_read_b32 v249, v253 offset:0
    s_waitcnt lgkmcnt(0)
    v_cmp_eq_u32 vcc, 0, v249
    s_nop 0
    s_cbranch_vccz WD_2
    s_sub_u32 s15, s15, 1
    s_cbranch_scc0 W_1
WD_2:
    ds_read_b128 v[128:131], v176 offset:0
    ds_read_b64_tr_b16 v[132:133], v177 offset:0
    ds_read_b64_tr_b16 v[134:135], v181 offset:0
    ds_read_b128 v[136:139], v176 offset:64
    ds_read_b64_tr_b16 v[140:141], v177 offset:1024
    ds_read_b64_tr_b16 v[142:143], v181 offset:1024
    ds_read_b128 v[144:147], v176 offset:128
    ds_read_b64_tr_b16 v[148:149], v177 offset:2048
    ds_read_b64_tr_b16 v[150:151], v181 offset:2048
    ds_read_b128 v[152:155], v176 offset:192
    ds_read_b64_tr_b16 v[156:157], v177 offset:3072
    ds_read_b64_tr_b16 v[158:159], v181 offset:3072
    s_bitcmp1_b32 s5, 0
    s_cbranch_scc1 L_kv_v
    s_waitcnt lgkmcnt(9)
    v_mfma_f32_16x16x32_bf16 v[184:187], v[132:135], v[128:131], 0
    s_waitcnt lgkmcnt(6)
    v_mfma_f32_16x16x32_bf16 v[184:187], v[140:143], v[136:139], v[184:187]
    s_waitcnt lgkmcnt(3)
    v_mfma_f32_16x16x32_bf16 v[184:187], v[148:151], v[144:147], v[184:187]
    s_waitcnt lgkmcnt(0)
    v_mfma_f32_16x16x32_bf16 v[184:187], v[156:159], v[152:155], v[184:187]
    s_branch L_kv_j
L_kv_v:
    s_waitcnt lgkmcnt(9)
    v_mfma_f32_16x16x32_bf16 v[184:187], v[128:131], v[132:135], 0
    s_waitcnt lgkmcnt(6)
    v_mfma_f32_16x16x32_bf16 v[184:187], v[136:139], v[140:143], v[184:187]
    s_waitcnt lgkmcnt(3)
    v_mfma_f32_16x16x32_bf16 v[184:187], v[144:147], v[148:151], v[184:187]
    s_waitcnt lgkmcnt(0)
    v_mfma_f32_16x16x32_bf16 v[184:187], v[152:155], v[156:159], v[184:187]
L_kv_j:
    s_cmp_eq_u32 s72, 0
    s_cbranch_scc1 L_kv_0
    s_nop 5
    ds_write_b128 v178, v[184:187] offset:5120
    ds_write_b32 v254, v255 offset:208
    s_branch L_nokv
L_kv_0:
    ds_write_b32 v254, v255 offset:208
    s_mov_b32 s15, 400000
W_3:
    ds_read_b32 v249, v253 offset:208
    s_waitcnt lgkmcnt(0)
    v_cmp_eq_u32 vcc, 0, v249
    s_nop 0
    s_cbranch_vccz WD_4
    s_sub_u32 s15, s15, 1
    s_cbranch_scc0 W_3
WD_4:
    ds_read_b128 v[128:131], v251 offset:6144
    ds_read_b128 v[132:135], v251 offset:7168
    ds_read_b128 v[136:139], v251 offset:8192
    s_waitcnt lgkmcnt(2)
    v_pk_add_f32 v[184:185], v[184:185], v[128:129]
    v_pk_add_f32 v[186:187], v[186:187], v[130:131]
    s_waitcnt lgkmcnt(1)
    v_pk_add_f32 v[184:185], v[184:185], v[132:133]
    v_pk_add_f32 v[186:187], v[186:187], v[134:135]
    s_waitcnt lgkmcnt(0)
    v_pk_add_f32 v[184:185], v[184:185], v[136:137]
    v_pk_add_f32 v[186:187], v[186:187], v[138:139]
    v_cvt_pk_bf16_f32 v188, v184, v185
    v_cvt_pk_bf16_f32 v189, v186, v187
    buffer_store_dwordx2 v[188:189], v179, s[64:67], s12 offen sc1
    s_bitcmp1_b32 s5, 0
    s_cbranch_scc1 L_kv_v2
    v_mul_f32 v190, v184, v184
    v_fmac_f32 v190, v185, v185
    v_fmac_f32 v190, v186, v186
    v_fmac_f32 v190, v187, v187
    v_mov_b32 v191, v190
    s_nop 1
    v_permlane32_swap_b32 v190, v191
    v_add_f32 v190, v190, v191
    v_mov_b32 v191, v190
    s_nop 1
    v_permlane16_swap_b32 v190, v191
    v_add_f32 v190, v190, v191
    s_mov_b64 exec, 0xffff
    s_branch L_kv_fin
L_kv_v2:
    v_max3_f32 v190, |v184|, |v185|, |v186|
    v_max_f32 v190, |v187|, v190
    s_mov_b32 s10, 0x58800000
    v_cmp_lt_f32 vcc, s10, v190
    v_mov_b32 v190, 0x7f800000
    s_mov_b64 exec, vcc
L_kv_fin:
    ds_max_u32 v180, v190 offset:408
    s_mov_b64 exec, -1
    ds_read_b32 v183, v180 offset:408
    s_waitcnt vmcnt(1)
    v_readfirstlane_b32 s8, v252
    s_nop 0
    s_mul_i32 s8, s8, 0x9E3779B1
    s_add_u32 s8, s8, 0x7F4A7C15
    v_mov_b32 v182, s8
    ds_write_b32 v253, v182 offset:416
L_nokv:
    s_cmp_eq_u32 s72, 0
    s_cbranch_scc1 L_pw1
    s_waitcnt vmcnt(0)
L_pw1:
    v_lshlrev_b32 v0, 16, v238
    v_lshlrev_b32 v1, 16, v239
    v_lshlrev_b32 v2, 16, v240
    v_mul_f32 v2, 0x3fb8aa3b, v2
    v_exp_f32 v2, v2
    s_nop 0
    v_cvt_pk_bf16_f32 v2, v2, v2
    v_lshlrev_b32 v2, 16, v2
    v_mul_f32 v4, v2, v0
    v_mul_f32 v5, v2, v1
    v_mul_f32 v4, 0x3fb8aa3b, v4
    v_mul_f32 v5, 0xbe22f983, v5
    v_mul_f32 v6, 1.0, v4
    v_mul_f32 v7, 1.0, v5
    v_exp_f32 v6, v6
    v_fract_f32 v7, v7
    v_cos_f32 v8, v7
    v_sin_f32 v9, v7
    v_mul_f32 v192, v6, v8
    v_mul_f32 v193, v6, v9
    v_mul_f32 v6, 0x41000000, v4
    v_mul_f32 v7, 0x41000000, v5
    v_exp_f32 v6, v6
    v_fract_f32 v7, v7
    v_cos_f32 v8, v7
    v_sin_f32 v9, v7
    v_mul_f32 v194, v6, v8
    v_mul_f32 v195, v6, v9
    v_mul_f32 v6, 0x41800000, v4
    v_mul_f32 v7, 0x41800000, v5
    v_exp_f32 v6, v6
    v_fract_f32 v7, v7
    v_cos_f32 v8, v7
    v_sin_f32 v9, v7
    v_mul_f32 v196, v6, v8
    v_mul_f32 v197, v6, v9
    v_mul_f32 v6, 0x43000000, v4
    v_mul_f32 v7, 0x43000000, v5
    v_exp_f32 v6, v6
    v_fract_f32 v7, v7
    v_cos_f32 v8, v7
    v_sin_f32 v9, v7
    v_mul_f32 v198, v6, v8
    v_mul_f32 v199, v6, v9
    v_cvt_f32_u32 v11, v243
    v_mul_f32 v11, 0x44800000, v11
    v_mul_f32 v6, v11, v4
    v_mul_f32 v7, v11, v5
    v_exp_f32 v6, v6
    v_fract_f32 v7, v7
    v_cos_f32 v8, v7
    v_sin_f32 v9, v7
    v_mul_f32 v200, v6, v8
    v_mul_f32 v201, v6, v9
    s_lshl_b32 s9, s72, 1
    v_add_u32 v11, s9, v243
    v_cvt_f32_u32 v11, v11
    v_mul_f32 v11, 0x41800000, v11
    v_mul_f32 v6, v11, v4
    v_mul_f32 v7, v11, v5
    v_exp_f32 v6, v6
    v_fract_f32 v7, v7
    v_cos_f32 v8, v7
    v_sin_f32 v9, v7
    v_mul_f32 v202, v6, v8
    v_mul_f32 v203, v6, v9
    v_add_f32 v6, -1.0, v192
    v_mul_f32 v7, v0, v0
    v_fmac_f32 v7, v1, v1
    v_rcp_f32 v7, v7
    s_nop 0
    v_add_f32 v7, v7, v7
    v_mul_f32 v8, v6, v0
    v_fma_f32 v8, -v193, v1, v8
    v_mul_f32 v9, v6, v1
    v_fma_f32 v9, -v193, v0, -v9
    v_mul_f32 v204, v8, v7
    v_mul_f32 v205, v9, v7
    v_and_b32 v6, 1, v250
    v_lshlrev_b32 v6, 4, v6
    v_lshlrev_b32 v3, v6, v241
    v_lshrrev_b32 v6, 1, v242
    v_lshlrev_b32 v7, 2, v243
    v_sub_u32 v6, v6, v7
    v_cmp_eq_u32 vcc, 0, v6
    s_nop 1
    v_cndmask_b32 v206, 0, v3, vcc
    v_cmp_eq_u32 vcc, 1, v6
    s_nop 1
    v_cndmask_b32 v207, 0, v3, vcc
    v_cmp_eq_u32 vcc, 2, v6
    s_nop 1
    v_cndmask_b32 v208, 0, v3, vcc
    v_cmp_eq_u32 vcc, 3, v6
    s_nop 1
    v_cndmask_b32 v209, 0, v3, vcc
    v_cmp_eq_u32 vcc, 8, v6
    s_nop 1
    v_cndmask_b32 v210, 0, v3, vcc
    v_cmp_eq_u32 vcc, 9, v6
    s_nop 1
    v_cndmask_b32 v211, 0, v3, vcc
    v_cmp_eq_u32 vcc, 10, v6
    s_nop 1
    v_cndmask_b32 v212, 0, v3, vcc
    v_cmp_eq_u32 vcc, 11, v6
    s_nop 1
    v_cndmask_b32 v213, 0, v3, vcc
    v_mov_b32 v238, 0
    v_mov_b32 v239, 0
    s_mov_b32 s15, 400000
W_5:
    ds_read_b32 v249, v253 offset:16
    s_waitcnt lgkmcnt(0)
    v_cmp_eq_u32 vcc, 0, v249
    s_nop 0
    s_cbranch_vccz WD_6
    s_sleep 1
    s_sub_u32 s15, s15, 1
    s_cbranch_scc0 W_5
WD_6:
    s_and_b32 s10, s4, 3
    s_xor_b32 s9, s10, 0
    s_lshl_b32 s9, s9, 8
    v_add_u32 v244, s9, v246
    s_xor_b32 s9, s10, 1
    s_lshl_b32 s9, s9, 8
    v_add_u32 v186, s9, v246
    s_xor_b32 s9, s10, 2
    s_lshl_b32 s9, s9, 8
    v_add_u32 v187, s9, v246
    s_xor_b32 s9, s10, 3
    s_lshl_b32 s9, s9, 8
    v_add_u32 v191, s9, v246
    ds_read_b128 v[64:67], v187 offset:0
    ds_read_b128 v[68:71], v187 offset:32
    ds_read_b128 v[72:75], v187 offset:64
    ds_read_b128 v[76:79], v187 offset:96
    ds_read_b128 v[80:83], v187 offset:128
    ds_read_b128 v[84:87], v187 offset:160
    ds_read_b128 v[88:91], v187 offset:192
    ds_read_b128 v[92:95], v187 offset:224
    ds_read_b128 v[96:99], v191 offset:0
    ds_read_b128 v[100:103], v191 offset:32
    ds_read_b128 v[104:107], v191 offset:64
    ds_read_b128 v[108:111], v191 offset:96
    ds_read_b128 v[112:115], v191 offset:128
    ds_read_b128 v[116:119], v191 offset:160
    ds_read_b128 v[120:123], v191 offset:192
    ds_read_b128 v[124:127], v191 offset:224
    s_cmp_lg_u32 s72, 0
    s_cbranch_scc1 L_nokvf
    s_waitcnt vmcnt(0)
    s_mov_b64 exec, 0xf
    buffer_store_dwordx4 v[182:185], v251, s[64:67], s13 offen sc1
    s_mov_b64 exec, -1
    ds_write_b32 v253, v255 offset:80
L_nokvf:
    s_mov_b32 s15, 400000
W_7:
    ds_read_b32 v249, v253 offset:32
    s_waitcnt lgkmcnt(0)
    v_cmp_eq_u32 vcc, 0, v249
    s_nop 0
    s_cbranch_vccz WD_8
    s_sub_u32 s15, s15, 1
    s_cbranch_scc0 W_7
WD_8:
    ds_read_b128 v[0:3], v244 offset:0
    ds_read_b64_tr_b16 v[128:129], v245 offset:0
    ds_read_b64_tr_b16 v[130:131], v245 offset:512
    ds_read_b128 v[4:7], v244 offset:32
    ds_read_b64_tr_b16 v[132:133], v245 offset:2048
    ds_read_b64_tr_b16 v[134:135], v245 offset:2560
    ds_read_b128 v[8:11], v244 offset:64
    ds_read_b64_tr_b16 v[136:137], v245 offset:4096
    ds_read_b64_tr_b16 v[138:139], v245 offset:4608
    ds_read_b128 v[12:15], v244 offset:96
    ds_read_b64_tr_b16 v[140:141], v245 offset:6144
    ds_read_b64_tr_b16 v[142:143], v245 offset:6656
    s_waitcnt lgkmcnt(9)
    v_mfma_f32_32x32x16_bf16 v[160:175], v[128:131], v[0:3], 0
    ds_read_b128 v[16:19], v244 offset:128
    ds_read_b64_tr_b16 v[144:145], v245 offset:8192
    ds_read_b64_tr_b16 v[146:147], v245 offset:8704
    s_waitcnt lgkmcnt(9)
    v_mfma_f32_32x32x16_bf16 v[160:175], v[132:135], v[4:7], v[160:175]
    ds_read_b128 v[20:23], v244 offset:160
    ds_read_b64_tr_b16 v[148:149], v245 offset:10240
    ds_read_b64_tr_b16 v[150:151], v245 offset:10752
    s_waitcnt lgkmcnt(9)
    v_mfma_f32_32x32x16_bf16 v[160:175], v[136:139], v[8:11], v[160:175]
    ds_read_b128 v[24:27], v244 offset:192
    ds_read_b64_tr_b16 v[152:153], v245 offset:12288
    ds_read_b64_tr_b16 v[154:155], v245 offset:12800
    s_waitcnt lgkmcnt(9)
    v_mfma_f32_32x32x16_bf16 v[160:175], v[140:143], v[12:15], v[160:175]
    ds_read_b128 v[28:31], v244 offset:224
    ds_read_b64_tr_b16 v[156:157], v245 offset:14336
    ds_read_b64_tr_b16 v[158:159], v245 offset:14848
    s_waitcnt lgkmcnt(9)
    v_mfma_f32_32x32x16_bf16 v[160:175], v[144:147], v[16:19], v[160:175]
    ds_read_b128 v[32:35], v186 offset:0
    ds_read_b64_tr_b16 v[128:129], v245 offset:16384
    ds_read_b64_tr_b16 v[130:131], v245 offset:16896
    s_waitcnt lgkmcnt(9)
    v_mfma_f32_32x32x16_bf16 v[160:175], v[148:151], v[20:23], v[160:175]
    ds_read_b128 v[36:39], v186 offset:32
    ds_read_b64_tr_b16 v[132:133], v245 offset:18432
    ds_read_b64_tr_b16 v[134:135], v245 offset:18944
    s_waitcnt lgkmcnt(9)
    v_mfma_f32_32x32x16_bf16 v[160:175], v[152:155], v[24:27], v[160:175]
    ds_read_b128 v[40:43], v186 offset:64
    ds_read_b64_tr_b16 v[136:137], v245 offset:20480
    ds_read_b64_tr_b16 v[138:139], v245 offset:20992
    s_waitcnt lgkmcnt(9)
    v_mfma_f32_32x32x16_bf16 v[160:175], v[156:159], v[28:31], v[160:175]
    ds_read_b128 v[44:47], v186 offset:96
    ds_read_b64_tr_b16 v[140:141], v245 offset:22528
    ds_read_b64_tr_b16 v[142:143], v245 offset:23040
    s_waitcnt lgkmcnt(9)
    v_mfma_f32_32x32x16_bf16 v[160:175], v[128:131], v[32:35], v[160:175]
    ds_read_b128 v[48:51], v186 offset:128
    ds_read_b64_tr_b16 v[144:145], v245 offset:24576
    ds_read_b64_tr_b16 v[146:147], v245 offset:25088
    s_waitcnt lgkmcnt(9)
    v_mfma_f32_32x32x16_bf16 v[160:175], v[132:135], v[36:39], v[160:175]
    ds_read_b128 v[52:55], v186 offset:160
    ds_read_b64_tr_b16 v[148:149], v245 offset:26624
    ds_read_b64_tr_b16 v[150:151], v245 offset:27136
    s_waitcnt lgkmcnt(9)
    v_mfma_f32_32x32x16_bf16 v[160:175], v[136:139], v[40:43], v[160:175]
    ds_read_b128 v[56:59], v186 offset:192
    ds_read_b64_tr_b16 v[152:153], v245 offset:28672
    ds_read_b64_tr_b16 v[154:155], v245 offset:29184
    s_waitcnt lgkmcnt(9)
    v_mfma_f32_32x32x16_bf16 v[160:175], v[140:143], v[44:47], v[160:175]
    ds_read_b128 v[60:63], v186 offset:224
    ds_read_b64_tr_b16 v[156:157], v245 offset:30720
    ds_read_b64_tr_b16 v[158:159], v245 offset:31232
    s_waitcnt lgkmcnt(9)
    v_mfma_f32_32x32x16_bf16 v[160:175], v[144:147], v[48:51], v[160:175]
    s_waitcnt lgkmcnt(6)
    v_mfma_f32_32x32x16_bf16 v[160:175], v[148:151], v[52:55], v[160:175]
    s_waitcnt lgkmcnt(3)
    v_mfma_f32_32x32x16_bf16 v[160:175], v[152:155], v[56:59], v[160:175]
    s_waitcnt lgkmcnt(0)
    v_mfma_f32_32x32x16_bf16 v[160:175], v[156:159], v[60:63], v[160:175]
    s_mov_b32 s15, 400000
W_9:
    ds_read_b32 v249, v253 offset:80
    s_waitcnt lgkmcnt(0)
    v_cmp_eq_u32 vcc, 0, v249
    s_nop 0
    s_cbranch_vccz WD_10
    s_sub_u32 s15, s15, 1
    s_cbranch_scc0 W_9
WD_10:
    ds_write_b32 v254, v255 offset:432
    ds_read_b32 v236, v253 offset:416
    s_mov_b32 s15, 400000
W_11:
    ds_read_b32 v249, v253 offset:48
    s_waitcnt lgkmcnt(0)
    v_cmp_eq_u32 vcc, 0, v249
    s_nop 0
    s_cbranch_vccz WD_12
    s_sub_u32 s15, s15, 1
    s_cbranch_scc0 W_11
WD_12:
    ds_read_b64_tr_b16 v[128:129], v245 offset:32768
    ds_read_b64_tr_b16 v[130:131], v245 offset:33280
    ds_read_b64_tr_b16 v[132:133], v245 offset:34816
    ds_read_b64_tr_b16 v[134:135], v245 offset:35328
    ds_read_b64_tr_b16 v[136:137], v245 offset:36864
    ds_read_b64_tr_b16 v[138:139], v245 offset:37376
    ds_read_b64_tr_b16 v[140:141], v245 offset:38912
    ds_read_b64_tr_b16 v[142:143], v245 offset:39424
    ds_read_b64_tr_b16 v[144:145], v245 offset:40960
    ds_read_b64_tr_b16 v[146:147], v245 offset:41472
    ds_read_b64_tr_b16 v[148:149], v245 offset:43008
    ds_read_b64_tr_b16 v[150:151], v245 offset:43520
    s_waitcnt lgkmcnt(10)
    v_mfma_f32_32x32x16_bf16 v[160:175], v[128:131], v[64:67], v[160:175]
    ds_read_b64_tr_b16 v[152:153], v245 offset:45056
    ds_read_b64_tr_b16 v[154:155], v245 offset:45568
    s_waitcnt lgkmcnt(10)
    v_mfma_f32_32x32x16_bf16 v[160:175], v[132:135], v[68:71], v[160:175]
    ds_read_b64_tr_b16 v[156:157], v245 offset:47104
    ds_read_b64_tr_b16 v[158:159], v245 offset:47616
    s_waitcnt lgkmcnt(10)
    v_mfma_f32_32x32x16_bf16 v[160:175], v[136:139], v[72:75], v[160:175]
    ds_read_b64_tr_b16 v[128:129], v245 offset:49152
    ds_read_b64_tr_b16 v[130:131], v245 offset:49664
    s_waitcnt lgkmcnt(10)
    v_mfma_f32_32x32x16_bf16 v[160:175], v[140:143], v[76:79], v[160:175]
    ds_read_b64_tr_b16 v[132:133], v245 offset:51200
    ds_read_b64_tr_b16 v[134:135], v245 offset:51712
    s_waitcnt lgkmcnt(10)
    v_mfma_f32_32x32x16_bf16 v[160:175], v[144:147], v[80:83], v[160:175]
    ds_read_b64_tr_b16 v[136:137], v245 offset:53248
    ds_read_b64_tr_b16 v[138:139], v245 offset:53760
    s_waitcnt lgkmcnt(10)
    v_mfma_f32_32x32x16_bf16 v[160:175], v[148:151], v[84:87], v[160:175]
    ds_read_b64_tr_b16 v[140:141], v245 offset:55296
    ds_read_b64_tr_b16 v[142:143], v245 offset:55808
    s_waitcnt lgkmcnt(10)
    v_mfma_f32_32x32x16_bf16 v[160:175], v[152:155], v[88:91], v[160:175]
    ds_read_b64_tr_b16 v[144:145], v245 offset:57344
    ds_read_b64_tr_b16 v[146:147], v245 offset:57856
    s_waitcnt lgkmcnt(10)
    v_mfma_f32_32x32x16_bf16 v[160:175], v[156:159], v[92:95], v[160:175]
    ds_read_b64_tr_b16 v[148:149], v245 offset:59392
    ds_read_b64_tr_b16 v[150:151], v245 offset:59904
    s_waitcnt lgkmcnt(10)
    v_mfma_f32_32x32x16_bf16 v[160:175], v[128:131], v[96:99], v[160:175]
    ds_read_b64_tr_b16 v[152:153], v245 offset:61440
    ds_read_b64_tr_b16 v[154:155], v245 offset:61952
    s_waitcnt lgkmcnt(10)
    v_mfma_f32_32x32x16_bf16 v[160:175], v[132:135], v[100:103], v[160:175]
    ds_read_b64_tr_b16 v[156:157], v245 offset:63488
    ds_read_b64_tr_b16 v[158:159], v245 offset:64000
    s_waitcnt lgkmcnt(10)
    v_mfma_f32_32x32x16_bf16 v[160:175], v[136:139], v[104:107], v[160:175]
    s_waitcnt lgkmcnt(8)
    v_mfma_f32_32x32x16_bf16 v[160:175], v[140:143], v[108:111], v[160:175]
    s_waitcnt lgkmcnt(6)
    v_mfma_f32_32x32x16_bf16 v[160:175], v[144:147], v[112:115], v[160:175]
    s_waitcnt lgkmcnt(4)
    v_mfma_f32_32x32x16_bf16 v[160:175], v[148:151], v[116:119], v[160:175]
    s_waitcnt lgkmcnt(2)
    v_mfma_f32_32x32x16_bf16 v[160:175], v[152:155], v[120:123], v[160:175]
    s_waitcnt lgkmcnt(0)
    v_mfma_f32_32x32x16_bf16 v[160:175], v[156:159], v[124:127], v[160:175]
    v_mov_b32 v24, 0x3eb8aa3b
    s_nop 10
    v_pk_mul_f32 v[160:161], v[24:25], v[160:161] op_sel:[0,0] op_sel_hi:[0,1]
    v_cvt_pk_bf16_f32 v16, v160, v161
    v_pk_mul_f32 v[162:163], v[24:25], v[162:163] op_sel:[0,0] op_sel_hi:[0,1]
    v_cvt_pk_bf16_f32 v17, v162, v163
    v_pk_mul_f32 v[164:165], v[24:25], v[164:165] op_sel:[0,0] op_sel_hi:[0,1]
    v_cvt_pk_bf16_f32 v18, v164, v165
    v_pk_mul_f32 v[166:167], v[24:25], v[166:167] op_sel:[0,0] op_sel_hi:[0,1]
    v_cvt_pk_bf16_f32 v19, v166, v167
    ds_write_b128 v247, v[16:19] offset:5120
    v_pk_mul_f32 v[168:169], v[24:25], v[168:169] op_sel:[0,0] op_sel_hi:[0,1]
    v_cvt_pk_bf16_f32 v20, v168, v169
    v_pk_mul_f32 v[170:171], v[24:25], v[170:171] op_sel:[0,0] op_sel_hi:[0,1]
    v_cvt_pk_bf16_f32 v21, v170, v171
    v_pk_mul_f32 v[172:173], v[24:25], v[172:173] op_sel:[0,0] op_sel_hi:[0,1]
    v_cvt_pk_bf16_f32 v22, v172, v173
    v_pk_mul_f32 v[174:175], v[24:25], v[174:175] op_sel:[0,0] op_sel_hi:[0,1]
    v_cvt_pk_bf16_f32 v23, v174, v175
    ds_write_b128 v247, v[20:23] offset:6144
    ds_write_b32 v254, v255 offset:64
    v_mul_f32 v8, v160, v160
    v_mul_f32 v9, v168, v168
    v_fmac_f32 v8, v161, v161
    v_fmac_f32 v9, v169, v169
    v_fmac_f32 v8, v162, v162
    v_fmac_f32 v9, v170, v170
    v_fmac_f32 v8, v163, v163
    v_fmac_f32 v9, v171, v171
    v_fmac_f32 v8, v164, v164
    v_fmac_f32 v9, v172, v172
    v_fmac_f32 v8, v165, v165
    v_fmac_f32 v9, v173, v173
    v_fmac_f32 v8, v166, v166
    v_fmac_f32 v9, v174, v174
    v_fmac_f32 v8, v167, v167
    v_fmac_f32 v9, v175, v175
    s_nop 1
    v_permlane32_swap_b32 v8, v9
    v_add_f32 v8, v8, v9
    v_mov_b32 v247, v8
    s_and_b32 s9, s5, 0
    s_lshl_b32 s9, s9, 7
    v_xor_b32 v246, s9, v251
    v_readfirstlane_b32 s8, v236
    v_mov_b32 v180, -1
    v_mov_b32 v181, -1
    v_mov_b32 v182, -1
    v_mov_b32 v183, -1
    v_mov_b32 v184, 0
    v_mov_b32 v185, 0
    v_mov_b32 v186, v236
    v_mov_b32 v187, 0
    s_mov_b32 s52, s26
    s_mov_b32 s53, s27
    s_mov_b32 s54, 0x200000
    s_mov_b32 s55, 0x20000
    s_mov_b32 s56, s32
    s_mov_b32 s57, s33
    s_mov_b32 s58, 0x80000
    s_mov_b32 s59, 0x20000
    s_mov_b32 s60, s34
    s_mov_b32 s61, s35
    s_mov_b32 s62, 0x80000
    s_mov_b32 s63, 0x20000
    s_mov_b32 s15, 400000
W_13:
    ds_read_b32 v249, v253 offset:96
    s_waitcnt lgkmcnt(0)
    v_cmp_eq_u32 vcc, 0, v249
    s_nop 0
    s_cbranch_vccz WD_14
    s_sleep 4
    s_sub_u32 s15, s15, 1
    s_cbranch_scc0 W_13
WD_14:
    ds_read_b64 v[188:189], v184 offset:400
    s_xor_b32 s9, s50, 0
    s_mul_i32 s9, s9, 1040
    s_add_u32 m0, s9, s74
    s_xor_b32 s9, s51, 0
    buffer_load_dwordx4 v214, s[52:55], s9 offen lds
    s_xor_b32 s9, s50, 1
    s_mul_i32 s9, s9, 1040
    s_add_u32 m0, s9, s74
    s_xor_b32 s9, s51, 1024
    buffer_load_dwordx4 v214, s[52:55], s9 offen lds
    s_mov_b32 s9, 0x45548000
    s_waitcnt lgkmcnt(0)
    v_mul_f32 v249, v188, v247
    v_cmp_nge_f32 vcc, s9, v249
    s_nop 0
    s_cmp_eq_u64 vcc, 0
    s_cselect_b32 s9, 1, 2
    v_mov_b32 v247, s9
    ds_write_b32 v254, v247 offset:144
    s_mul_i32 s10, s72, 4160
    s_lshl_b32 s11, s7, 15
    s_lshl_b32 s12, s72, 13
    s_add_u32 s11, s11, s12
    s_add_u32 s11, s11, s81
    s_add_u32 m0, s10, 29696
    s_xor_b32 s9, s11, 0
    buffer_load_dwordx4 v217, s[56:59], s9 offen lds
    s_add_u32 m0, s10, 30736
    s_xor_b32 s9, s11, 2048
    buffer_load_dwordx4 v217, s[56:59], s9 offen lds
    s_add_u32 m0, s10, 31776
    s_xor_b32 s9, s11, 4096
    buffer_load_dwordx4 v217, s[56:59], s9 offen lds
    s_add_u32 m0, s10, 32816
    s_xor_b32 s9, s11, 6144
    buffer_load_dwordx4 v217, s[56:59], s9 offen lds
    s_add_u32 m0, s10, 46336
    s_xor_b32 s9, s11, 0
    buffer_load_dwordx4 v217, s[60:63], s9 offen lds
    s_add_u32 m0, s10, 47376
    s_xor_b32 s9, s11, 2048
    buffer_load_dwordx4 v217, s[60:63], s9 offen lds
    s_add_u32 m0, s10, 48416
    s_xor_b32 s9, s11, 4096
    buffer_load_dwordx4 v217, s[60:63], s9 offen lds
    s_add_u32 m0, s10, 49456
    s_xor_b32 s9, s11, 6144
    buffer_load_dwordx4 v217, s[60:63], s9 offen lds
    s_xor_b32 s9, s50, 2
    s_mul_i32 s9, s9, 1040
    s_add_u32 m0, s9, s74
    s_xor_b32 s9, s51, 16384
    buffer_load_dwordx4 v214, s[52:55], s9 offen lds
    s_xor_b32 s9, s50, 3
    s_mul_i32 s9, s9, 1040
    s_add_u32 m0, s9, s74
    s_xor_b32 s9, s51, 17408
    buffer_load_dwordx4 v214, s[52:55], s9 offen lds
    s_xor_b32 s9, s50, 4
    s_mul_i32 s9, s9, 1040
    s_add_u32 m0, s9, s74
    s_xor_b32 s9, s51, 2048
    buffer_load_dwordx4 v214, s[52:55], s9 offen lds
    s_xor_b32 s9, s50, 5
    s_mul_i32 s9, s9, 1040
    s_add_u32 m0, s9, s74
    s_xor_b32 s9, s51, 3072
    buffer_load_dwordx4 v214, s[52:55], s9 offen lds
    s_xor_b32 s9, s50, 6
    s_mul_i32 s9, s9, 1040
    s_add_u32 m0, s9, s74
    s_xor_b32 s9, s51, 18432
    buffer_load_dwordx4 v214, s[52:55], s9 offen lds
    s_xor_b32 s9, s50, 7
    s_mul_i32 s9, s9, 1040
    s_add_u32 m0, s9, s74
    s_xor_b32 s9, s51, 19456
    buffer_load_dwordx4 v214, s[52:55], s9 offen lds
    s_xor_b32 s9, s50, 8
    s_mul_i32 s9, s9, 1040
    s_add_u32 m0, s9, s74
    s_xor_b32 s9, s51, 4096
    buffer_load_dwordx4 v214, s[52:55], s9 offen lds
    s_xor_b32 s9, s50, 9
    s_mul_i32 s9, s9, 1040
    s_add_u32 m0, s9, s74
    s_xor_b32 s9, s51, 5120
    buffer_load_dwordx4 v214, s[52:55], s9 offen lds
    s_xor_b32 s9, s50, 10
    s_mul_i32 s9, s9, 1040
    s_add_u32 m0, s9, s74
    s_xor_b32 s9, s51, 20480
    buffer_load_dwordx4 v214, s[52:55], s9 offen lds
    s_xor_b32 s9, s50, 11
    s_mul_i32 s9, s9, 1040
    s_add_u32 m0, s9, s74
    s_xor_b32 s9, s51, 21504
    buffer_load_dwordx4 v214, s[52:55], s9 offen lds
    s_xor_b32 s9, s50, 12
    s_mul_i32 s9, s9, 1040
    s_add_u32 m0, s9, s74
    s_xor_b32 s9, s51, 6144
    buffer_load_dwordx4 v214, s[52:55], s9 offen lds
    s_xor_b32 s9, s50, 13
    s_mul_i32 s9, s9, 1040
    s_add_u32 m0, s9, s74
    s_xor_b32 s9, s51, 7168
    buffer_load_dwordx4 v214, s[52:55], s9 offen lds
    s_xor_b32 s9, s50, 14
    s_mul_i32 s9, s9, 1040
    s_add_u32 m0, s9, s74
    s_xor_b32 s9, s51, 22528
    buffer_load_dwordx4 v214, s[52:55], s9 offen lds
    s_xor_b32 s9, s50, 15
    s_mul_i32 s9, s9, 1040
    s_add_u32 m0, s9, s74
    s_xor_b32 s9, s51, 23552
    buffer_load_dwordx4 v214, s[52:55], s9 offen lds
    s_waitcnt vmcnt(0)
    ds_write_b32 v254, v255 offset:160
    ds_read_b128 v[0:3], v215 offset:0
    ds_read_b128 v[4:7], v215 offset:32
    ds_read_b128 v[8:11], v215 offset:64
    ds_read_b128 v[12:15], v215 offset:96
    ds_read_b128 v[16:19], v216 offset:128
    ds_read_b128 v[20:23], v216 offset:160
    ds_read_b128 v[24:27], v216 offset:192
    ds_read_b128 v[28:31], v216 offset:224
    ds_read_b128 v[32:35], v215 offset:256
    ds_read_b128 v[36:39], v215 offset:288
    ds_read_b128 v[40:43], v215 offset:320
    ds_read_b128 v[44:47], v215 offset:352
    ds_read_b128 v[48:51], v216 offset:384
    ds_read_b128 v[52:55], v216 offset:416
    ds_read_b128 v[56:59], v216 offset:448
    ds_read_b128 v[60:63], v216 offset:480
    s_mov_b32 s15, 400000
W_15:
    ds_read_b32 v249, v253 offset:160
    s_waitcnt lgkmcnt(0)
    v_cmp_eq_u32 vcc, 0, v249
    s_nop 0
    s_cbranch_vccz WD_16
    s_sleep 1
    s_sub_u32 s15, s15, 1
    s_cbranch_scc0 W_15
WD_16:
    s_setprio 0
    ds_read_b128 v[160:163], v218 offset:0
    ds_read_b128 v[164:167], v218 offset:16640
    s_waitcnt lgkmcnt(0)
    v_mfma_f32_32x32x16_bf16 v[128:143], v[0:3], v[160:163], 0
    v_mfma_f32_32x32x16_bf16 v[144:159], v[0:3], v[164:167], 0
    ds_read_b128 v[168:171], v218 offset:32
    ds_read_b128 v[172:175], v218 offset:16672
    s_add_u32 m0, s10, 62976
    s_xor_b32 s9, s11, 512
    buffer_load_dwordx4 v217, s[56:59], s9 offen lds
    s_add_u32 m0, s10, 64016
    s_xor_b32 s9, s11, 2560
    buffer_load_dwordx4 v217, s[56:59], s9 offen lds
    s_add_u32 m0, s10, 65056
    s_xor_b32 s9, s11, 4608
    buffer_load_dwordx4 v217, s[56:59], s9 offen lds
    s_add_u32 m0, s10, 66096
    s_xor_b32 s9, s11, 6656
    buffer_load_dwordx4 v217, s[56:59], s9 offen lds
    s_waitcnt lgkmcnt(0)
    v_mfma_f32_32x32x16_bf16 v[128:143], v[4:7], v[168:171], v[128:143]
    v_mfma_f32_32x32x16_bf16 v[144:159], v[4:7], v[172:175], v[144:159]
    ds_read_b128 v[160:163], v218 offset:64
    ds_read_b128 v[164:167], v218 offset:16704
    s_add_u32 m0, s10, 79616
    s_xor_b32 s9, s11, 512
    buffer_load_dwordx4 v217, s[60:63], s9 offen lds
    s_add_u32 m0, s10, 80656
    s_xor_b32 s9, s11, 2560
    buffer_load_dwordx4 v217, s[60:63], s9 offen lds
    s_add_u32 m0, s10, 81696
    s_xor_b32 s9, s11, 4608
    buffer_load_dwordx4 v217, s[60:63], s9 offen lds
    s_add_u32 m0, s10, 82736
    s_xor_b32 s9, s11, 6656
    buffer_load_dwordx4 v217, s[60:63], s9 offen lds
    s_waitcnt lgkmcnt(0)
    v_mfma_f32_32x32x16_bf16 v[128:143], v[8:11], v[160:163], v[128:143]
    v_mfma_f32_32x32x16_bf16 v[144:159], v[8:11], v[164:167], v[144:159]
    ds_read_b128 v[168:171], v218 offset:96
    ds_read_b128 v[172:175], v218 offset:16736
    s_xor_b32 s9, s50, 0
    s_mul_i32 s9, s9, 1040
    s_add_u32 m0, s9, s74
    s_xor_b32 s9, s51, 512
    buffer_load_dwordx4 v214, s[52:55], s9 offen lds
    s_xor_b32 s9, s50, 1
    s_mul_i32 s9, s9, 1040
    s_add_u32 m0, s9, s74
    s_xor_b32 s9, s51, 1536
    buffer_load_dwordx4 v214, s[52:55], s9 offen lds
    s_xor_b32 s9, s50, 2
    s_mul_i32 s9, s9, 1040
    s_add_u32 m0, s9, s74
    s_xor_b32 s9, s51, 16896
    buffer_load_dwordx4 v214, s[52:55], s9 offen lds
    s_xor_b32 s9, s50, 3
    s_mul_i32 s9, s9, 1040
    s_add_u32 m0, s9, s74
    s_xor_b32 s9, s51, 17920
    buffer_load_dwordx4 v214, s[52:55], s9 offen lds
    s_waitcnt lgkmcnt(0)
    v_mfma_f32_32x32x16_bf16 v[128:143], v[12:15], v[168:171], v[128:143]
    v_mfma_f32_32x32x16_bf16 v[144:159], v[12:15], v[172:175], v[144:159]
    ds_read_b128 v[160:163], v219 offset:128
    ds_read_b128 v[164:167], v219 offset:16768
    s_xor_b32 s9, s50, 4
    s_mul_i32 s9, s9, 1040
    s_add_u32 m0, s9, s74
    s_xor_b32 s9, s51, 2560
    buffer_load_dwordx4 v214, s[52:55], s9 offen lds
    s_xor_b32 s9, s50, 5
    s_mul_i32 s9, s9, 1040
    s_add_u32 m0, s9, s74
    s_xor_b32 s9, s51, 3584
    buffer_load_dwordx4 v214, s[52:55], s9 offen lds
    s_xor_b32 s9, s50, 6
    s_mul_i32 s9, s9, 1040
    s_add_u32 m0, s9, s74
    s_xor_b32 s9, s51, 18944
    buffer_load_dwordx4 v214, s[52:55], s9 offen lds
    s_xor_b32 s9, s50, 7
    s_mul_i32 s9, s9, 1040
    s_add_u32 m0, s9, s74
    s_xor_b32 s9, s51, 19968
    buffer_load_dwordx4 v214, s[52:55], s9 offen lds
    s_waitcnt lgkmcnt(0)
    v_mfma_f32_32x32x16_bf16 v[128:143], v[16:19], v[160:163], v[128:143]
    v_mfma_f32_32x32x16_bf16 v[144:159], v[16:19], v[164:167], v[144:159]
    ds_read_b128 v[168:171], v219 offset:160
    ds_read_b128 v[172:175], v219 offset:16800
    s_xor_b32 s9, s50, 8
    s_mul_i32 s9, s9, 1040
    s_add_u32 m0, s9, s74
    s_xor_b32 s9, s51, 4608
    buffer_load_dwordx4 v214, s[52:55], s9 offen lds
    s_xor_b32 s9, s50, 9
    s_mul_i32 s9, s9, 1040
    s_add_u32 m0, s9, s74
    s_xor_b32 s9, s51, 5632
    buffer_load_dwordx4 v214, s[52:55], s9 offen lds
    s_xor_b32 s9, s50, 10
    s_mul_i32 s9, s9, 1040
    s_add_u32 m0, s9, s74
    s_xor_b32 s9, s51, 20992
    buffer_load_dwordx4 v214, s[52:55], s9 offen lds
    s_xor_b32 s9, s50, 11
    s_mul_i32 s9, s9, 1040
    s_add_u32 m0, s9, s74
    s_xor_b32 s9, s51, 22016
    buffer_load_dwordx4 v214, s[52:55], s9 offen lds
    s_waitcnt lgkmcnt(0)
    v_mfma_f32_32x32x16_bf16 v[128:143], v[20:23], v[168:171], v[128:143]
    v_mfma_f32_32x32x16_bf16 v[144:159], v[20:23], v[172:175], v[144:159]
    ds_read_b128 v[160:163], v219 offset:192
    ds_read_b128 v[164:167], v219 offset:16832
    s_xor_b32 s9, s50, 12
    s_mul_i32 s9, s9, 1040
    s_add_u32 m0, s9, s74
    s_xor_b32 s9, s51, 6656
    buffer_load_dwordx4 v214, s[52:55], s9 offen lds
    s_xor_b32 s9, s50, 13
    s_mul_i32 s9, s9, 1040
    s_add_u32 m0, s9, s74
    s_xor_b32 s9, s51, 7680
    buffer_load_dwordx4 v214, s[52:55], s9 offen lds
    s_xor_b32 s9, s50, 14
    s_mul_i32 s9, s9, 1040
    s_add_u32 m0, s9, s74
    s_xor_b32 s9, s51, 23040
    buffer_load_dwordx4 v214, s[52:55], s9 offen lds
    s_xor_b32 s9, s50, 15
    s_mul_i32 s9, s9, 1040
    s_add_u32 m0, s9, s74
    s_xor_b32 s9, s51, 24064
    buffer_load_dwordx4 v214, s[52:55], s9 offen lds
    s_waitcnt lgkmcnt(0)
    v_mfma_f32_32x32x16_bf16 v[128:143], v[24:27], v[160:163], v[128:143]
    v_mfma_f32_32x32x16_bf16 v[144:159], v[24:27], v[164:167], v[144:159]
    ds_read_b128 v[168:171], v219 offset:224
    ds_read_b128 v[172:175], v219 offset:16864
    s_waitcnt lgkmcnt(0)
    v_mfma_f32_32x32x16_bf16 v[128:143], v[28:31], v[168:171], v[128:143]
    v_mfma_f32_32x32x16_bf16 v[144:159], v[28:31], v[172:175], v[144:159]
    ds_read_b128 v[160:163], v218 offset:256
    ds_read_b128 v[164:167], v218 offset:16896
    s_waitcnt lgkmcnt(0)
    v_mfma_f32_32x32x16_bf16 v[128:143], v[32:35], v[160:163], v[128:143]
    v_mfma_f32_32x32x16_bf16 v[144:159], v[32:35], v[164:167], v[144:159]
    ds_read_b128 v[168:171], v218 offset:288
    ds_read_b128 v[172:175], v218 offset:16928
    s_waitcnt lgkmcnt(0)
    v_mfma_f32_32x32x16_bf16 v[128:143], v[36:39], v[168:171], v[128:143]
    v_mfma_f32_32x32x16_bf16 v[144:159], v[36:39], v[172:175], v[144:159]
    ds_read_b128 v[160:163], v218 offset:320
    ds_read_b128 v[164:167], v218 offset:16960
    s_waitcnt lgkmcnt(0)
    v_mfma_f32_32x32x16_bf16 v[128:143], v[40:43], v[160:163], v[128:143]
    v_mfma_f32_32x32x16_bf16 v[144:159], v[40:43], v[164:167], v[144:159]
    ds_read_b128 v[168:171], v218 offset:352
    ds_read_b128 v[172:175], v218 offset:16992
    s_waitcnt vmcnt(0)
    ds_write_b32 v254, v255 offset:176
    s_or_b32 s9, s2, s72
    s_cbranch_scc1 L_noep
    s_mov_b64 exec, 1
    buffer_store_dword v236, off, s[64:67], 0 sc1
    s_mov_b64 exec, -1
L_noep:
    s_cmp_lg_u32 s6, 0
    s_cbranch_scc1 L_nozero
    s_lshl_b32 s9, s7, 14
    s_lshl_b32 s10, s72, 11
    s_add_u32 s9, s9, s10
    s_add_u32 s9, s9, 0x40000
    buffer_store_dwordx4 v[184:187], v251, s[64:67], s9 offen offset:0 sc1
    buffer_store_dwordx4 v[184:187], v251, s[64:67], s9 offen offset:1024 sc1
L_nozero:
    s_lshr_b32 s9, s72, 1
    s_and_b32 s10, s4, 1
    s_cmp_lg_u32 s9, s10
    s_cbranch_scc1 L_nosent
    s_lshl_b32 s10, s5, 12
    s_add_u32 s9, s73, s10
    s_add_u32 s9, s9, 0x100000
    buffer_store_dwordx4 v[180:183], v251, s[64:67], s9 offen offset:0 sc1
    buffer_store_dwordx4 v[180:183], v251, s[64:67], s9 offen offset:1024 sc1
    buffer_store_dwordx4 v[180:183], v251, s[64:67], s9 offen offset:2048 sc1
    buffer_store_dwordx4 v[180:183], v251, s[64:67], s9 offen offset:3072 sc1
L_nosent:
    s_lshr_b32 s9, s2, 3
    s_lshl_b32 s9, s9, 2
    s_add_u32 s9, s9, s72
    s_lshl_b32 s9, s9, 12
    s_mov_b32 s68, s36
    s_mov_b32 s69, s37
    s_mov_b32 s70, 0x80000
    s_mov_b32 s71, 0x20000
    buffer_load_dword v252, v235, s[68:71], s9 offen
    s_mov_b32 s68, s38
    s_mov_b32 s69, s39
    s_mov_b32 s70, 0x80000
    s_mov_b32 s71, 0x20000
    buffer_load_dword v252, v235, s[68:71], s9 offen
    s_mov_b32 s68, s24
    s_mov_b32 s69, s25
    s_mov_b32 s70, 0x80000
    s_mov_b32 s71, 0x20000
    buffer_load_dword v252, v235, s[68:71], s9 offen
    s_waitcnt lgkmcnt(1)
    v_mfma_f32_32x32x16_bf16 v[128:143], v[44:47], v[168:171], v[128:143]
    v_mfma_f32_32x32x16_bf16 v[144:159], v[44:47], v[172:175], v[144:159]
    ds_read_b128 v[64:67], v215 offset:0
    ds_read_b128 v[160:163], v219 offset:384
    ds_read_b128 v[164:167], v219 offset:17024
    s_waitcnt lgkmcnt(0)
    v_mfma_f32_32x32x16_bf16 v[128:143], v[48:51], v[160:163], v[128:143]
    v_mfma_f32_32x32x16_bf16 v[144:159], v[48:51], v[164:167], v[144:159]
    ds_read_b128 v[68:71], v215 offset:32
    ds_read_b128 v[168:171], v219 offset:416
    ds_read_b128 v[172:175], v219 offset:17056
    s_waitcnt lgkmcnt(0)
    v_mfma_f32_32x32x16_bf16 v[128:143], v[52:55], v[168:171], v[128:143]
    v_mfma_f32_32x32x16_bf16 v[144:159], v[52:55], v[172:175], v[144:159]
    ds_read_b128 v[72:75], v215 offset:64
    ds_read_b128 v[160:163], v219 offset:448
    ds_read_b128 v[164:167], v219 offset:17088
    s_waitcnt lgkmcnt(0)
    v_mfma_f32_32x32x16_bf16 v[128:143], v[56:59], v[160:163], v[128:143]
    v_mfma_f32_32x32x16_bf16 v[144:159], v[56:59], v[164:167], v[144:159]
    ds_read_b128 v[76:79], v215 offset:96
    ds_read_b128 v[168:171], v219 offset:480
    ds_read_b128 v[172:175], v219 offset:17120
    s_waitcnt lgkmcnt(0)
    v_mfma_f32_32x32x16_bf16 v[128:143], v[60:63], v[168:171], v[128:143]
    v_mfma_f32_32x32x16_bf16 v[144:159], v[60:63], v[172:175], v[144:159]
    s_setprio 3
    s_mov_b32 s15, 400000
W_17:
    ds_read_b32 v249, v253 offset:176
    s_waitcnt lgkmcnt(0)
    v_cmp_eq_u32 vcc, 0, v249
    s_nop 0
    s_cbranch_vccz WD_18
    s_sleep 1
    s_sub_u32 s15, s15, 1
    s_cbranch_scc0 W_17
WD_18:
    s_setprio 0
    ds_read_b128 v[80:83], v216 offset:128
    ds_read_b128 v[160:163], v218 offset:33280
    ds_read_b128 v[164:167], v218 offset:49920
    s_waitcnt lgkmcnt(0)
    v_mfma_f32_32x32x16_bf16 v[128:143], v[64:67], v[160:163], v[128:143]
    v_mfma_f32_32x32x16_bf16 v[144:159], v[64:67], v[164:167], v[144:159]
    ds_read_b128 v[84:87], v216 offset:160
    ds_read_b128 v[168:171], v218 offset:33312
    ds_read_b128 v[172:175], v218 offset:49952
    s_waitcnt lgkmcnt(0)
    v_mfma_f32_32x32x16_bf16 v[128:143], v[68:71], v[168:171], v[128:143]
    v_mfma_f32_32x32x16_bf16 v[144:159], v[68:71], v[172:175], v[144:159]
    ds_read_b128 v[88:91], v216 offset:192
    ds_read_b128 v[160:163], v218 offset:33344
    ds_read_b128 v[164:167], v218 offset:49984
    s_waitcnt lgkmcnt(0)
    v_mfma_f32_32x32x16_bf16 v[128:143], v[72:75], v[160:163], v[128:143]
    v_mfma_f32_32x32x16_bf16 v[144:159], v[72:75], v[164:167], v[144:159]
    ds_read_b128 v[92:95], v216 offset:224
    ds_read_b128 v[168:171], v218 offset:33376
    ds_read_b128 v[172:175], v218 offset:50016
    s_waitcnt lgkmcnt(0)
    v_mfma_f32_32x32x16_bf16 v[128:143], v[76:79], v[168:171], v[128:143]
    v_mfma_f32_32x32x16_bf16 v[144:159], v[76:79], v[172:175], v[144:159]
    ds_read_b128 v[96:99], v215 offset:256
    ds_read_b128 v[160:163], v219 offset:33408
    ds_read_b128 v[164:167], v219 offset:50048
    s_waitcnt lgkmcnt(0)
    v_mfma_f32_32x32x16_bf16 v[128:143], v[80:83], v[160:163], v[128:143]
    v_mfma_f32_32x32x16_bf16 v[144:159], v[80:83], v[164:167], v[144:159]
    ds_read_b128 v[100:103], v215 offset:288
    ds_read_b128 v[168:171], v219 offset:33440
    ds_read_b128 v[172:175], v219 offset:50080
    s_waitcnt lgkmcnt(0)
    v_mfma_f32_32x32x16_bf16 v[128:143], v[84:87], v[168:171], v[128:143]
    v_mfma_f32_32x32x16_bf16 v[144:159], v[84:87], v[172:175], v[144:159]
    ds_read_b128 v[104:107], v215 offset:320
    ds_read_b128 v[160:163], v219 offset:33472
    ds_read_b128 v[164:167], v219 offset:50112
    s_waitcnt lgkmcnt(0)
    v_mfma_f32_32x32x16_bf16 v[128:143], v[88:91], v[160:163], v[128:143]
    v_mfma_f32_32x32x16_bf16 v[144:159], v[88:91], v[164:167], v[144:159]
    ds_read_b128 v[108:111], v215 offset:352
    ds_read_b128 v[168:171], v219 offset:33504
    ds_read_b128 v[172:175], v219 offset:50144
    s_waitcnt lgkmcnt(0)
    v_mfma_f32_32x32x16_bf16 v[128:143], v[92:95], v[168:171], v[128:143]
    v_mfma_f32_32x32x16_bf16 v[144:159], v[92:95], v[172:175], v[144:159]
    ds_read_b128 v[112:115], v216 offset:384
    ds_read_b128 v[160:163], v218 offset:33536
    ds_read_b128 v[164:167], v218 offset:50176
    s_waitcnt lgkmcnt(0)
    v_mfma_f32_32x32x16_bf16 v[128:143], v[96:99], v[160:163], v[128:143]
    v_mfma_f32_32x32x16_bf16 v[144:159], v[96:99], v[164:167], v[144:159]
    ds_read_b128 v[116:119], v216 offset:416
    ds_read_b128 v[168:171], v218 offset:33568
    ds_read_b128 v[172:175], v218 offset:50208
    s_waitcnt lgkmcnt(0)
    v_mfma_f32_32x32x16_bf16 v[128:143], v[100:103], v[168:171], v[128:143]
    v_mfma_f32_32x32x16_bf16 v[144:159], v[100:103], v[172:175], v[144:159]
    ds_read_b128 v[120:123], v216 offset:448
    ds_read_b128 v[160:163], v218 offset:33600
    ds_read_b128 v[164:167], v218 offset:50240
    s_waitcnt lgkmcnt(0)
    v_mfma_f32_32x32x16_bf16 v[128:143], v[104:107], v[160:163], v[128:143]
    v_mfma_f32_32x32x16_bf16 v[144:159], v[104:107], v[164:167], v[144:159]
    ds_read_b128 v[124:127], v216 offset:480
    ds_read_b128 v[168:171], v218 offset:33632
    ds_read_b128 v[172:175], v218 offset:50272
    s_waitcnt lgkmcnt(0)
    v_mfma_f32_32x32x16_bf16 v[128:143], v[108:111], v[168:171], v[128:143]
    v_mfma_f32_32x32x16_bf16 v[144:159], v[108:111], v[172:175], v[144:159]
    ds_read_b128 v[160:163], v219 offset:33664
    ds_read_b128 v[164:167], v219 offset:50304
    s_waitcnt lgkmcnt(0)
    v_mfma_f32_32x32x16_bf16 v[128:143], v[112:115], v[160:163], v[128:143]
    v_mfma_f32_32x32x16_bf16 v[144:159], v[112:115], v[164:167], v[144:159]
    ds_read_b128 v[168:171], v219 offset:33696
    ds_read_b128 v[172:175], v219 offset:50336
    s_waitcnt lgkmcnt(0)
    v_mfma_f32_32x32x16_bf16 v[128:143], v[116:119], v[168:171], v[128:143]
    v_mfma_f32_32x32x16_bf16 v[144:159], v[116:119], v[172:175], v[144:159]
    ds_read_b128 v[160:163], v219 offset:33728
    ds_read_b128 v[164:167], v219 offset:50368
    s_waitcnt lgkmcnt(0)
    v_mfma_f32_32x32x16_bf16 v[128:143], v[120:123], v[160:163], v[128:143]
    v_mfma_f32_32x32x16_bf16 v[144:159], v[120:123], v[164:167], v[144:159]
    ds_read_b128 v[168:171], v219 offset:33760
    ds_read_b128 v[172:175], v219 offset:50400
    s_waitcnt lgkmcnt(0)
    v_mfma_f32_32x32x16_bf16 v[128:143], v[124:127], v[168:171], v[128:143]
    v_mfma_f32_32x32x16_bf16 v[144:159], v[124:127], v[172:175], v[144:159]
    s_setprio 3
    s_nop 10
    v_pk_fma_f32 v[8:9], v[192:193], v[144:145], v[130:131] op_sel:[1,0,0] op_sel_hi:[1,1,1] neg_lo:[0,0,0] neg_hi:[0,0,0]
    v_pk_fma_f32 v[10:11], v[192:193], v[128:129], v[146:147] op_sel:[1,0,0] op_sel_hi:[1,1,1] neg_lo:[0,0,1] neg_hi:[0,0,1]
    v_pk_fma_f32 v[12:13], v[192:193], v[128:129], v[8:9] op_sel:[0,0,0] op_sel_hi:[0,1,1]
    v_pk_fma_f32 v[14:15], v[192:193], v[144:145], v[10:11] op_sel:[0,0,0] op_sel_hi:[0,1,1] neg_lo:[1,0,0] neg_hi:[1,0,0]
    v_pk_fma_f32 v[8:9], v[192:193], v[14:15], v[132:133] op_sel:[1,0,0] op_sel_hi:[1,1,1] neg_lo:[1,0,0] neg_hi:[1,0,0]
    v_pk_fma_f32 v[10:11], v[192:193], v[12:13], v[148:149] op_sel:[1,0,0] op_sel_hi:[1,1,1] neg_lo:[0,0,1] neg_hi:[0,0,1]
    v_pk_fma_f32 v[12:13], v[192:193], v[12:13], v[8:9] op_sel:[0,0,0] op_sel_hi:[0,1,1]
    v_pk_fma_f32 v[14:15], v[192:193], v[14:15], v[10:11] op_sel:[0,0,0] op_sel_hi:[0,1,1] neg_lo:[0,0,0] neg_hi:[0,0,0]
    v_pk_fma_f32 v[8:9], v[192:193], v[14:15], v[134:135] op_sel:[1,0,0] op_sel_hi:[1,1,1] neg_lo:[1,0,0] neg_hi:[1,0,0]
    v_pk_fma_f32 v[10:11], v[192:193], v[12:13], v[150:151] op_sel:[1,0,0] op_sel_hi:[1,1,1] neg_lo:[0,0,1] neg_hi:[0,0,1]
    v_pk_fma_f32 v[12:13], v[192:193], v[12:13], v[8:9] op_sel:[0,0,0] op_sel_hi:[0,1,1]
    v_pk_fma_f32 v[14:15], v[192:193], v[14:15], v[10:11] op_sel:[0,0,0] op_sel_hi:[0,1,1] neg_lo:[0,0,0] neg_hi:[0,0,0]
    v_pk_fma_f32 v[8:9], v[192:193], v[14:15], v[136:137] op_sel:[1,0,0] op_sel_hi:[1,1,1] neg_lo:[1,0,0] neg_hi:[1,0,0]
    v_pk_fma_f32 v[10:11], v[192:193], v[12:13], v[152:153] op_sel:[1,0,0] op_sel_hi:[1,1,1] neg_lo:[0,0,1] neg_hi:[0,0,1]
    v_pk_fma_f32 v[12:13], v[192:193], v[12:13], v[8:9] op_sel:[0,0,0] op_sel_hi:[0,1,1]
    v_pk_fma_f32 v[14:15], v[192:193], v[14:15], v[10:11] op_sel:[0,0,0] op_sel_hi:[0,1,1] neg_lo:[0,0,0] neg_hi:[0,0,0]
    v_pk_fma_f32 v[8:9], v[192:193], v[14:15], v[138:139] op_sel:[1,0,0] op_sel_hi:[1,1,1] neg_lo:[1,0,0] neg_hi:[1,0,0]
    v_pk_fma_f32 v[10:11], v[192:193], v[12:13], v[154:155] op_sel:[1,0,0] op_sel_hi:[1,1,1] neg_lo:[0,0,1] neg_hi:[0,0,1]
    v_pk_fma_f32 v[12:13], v[192:193], v[12:13], v[8:9] op_sel:[0,0,0] op_sel_hi:[0,1,1]
    v_pk_fma_f32 v[14:15], v[192:193], v[14:15], v[10:11] op_sel:[0,0,0] op_sel_hi:[0,1,1] neg_lo:[0,0,0] neg_hi:[0,0,0]
    v_pk_fma_f32 v[8:9], v[192:193], v[14:15], v[140:141] op_sel:[1,0,0] op_sel_hi:[1,1,1] neg_lo:[1,0,0] neg_hi:[1,0,0]
    v_pk_fma_f32 v[10:11], v[192:193], v[12:13], v[156:157] op_sel:[1,0,0] op_sel_hi:[1,1,1] neg_lo:[0,0,1] neg_hi:[0,0,1]
    v_pk_fma_f32 v[12:13], v[192:193], v[12:13], v[8:9] op_sel:[0,0,0] op_sel_hi:[0,1,1]
    v_pk_fma_f32 v[14:15], v[192:193], v[14:15], v[10:11] op_sel:[0,0,0] op_sel_hi:[0,1,1] neg_lo:[0,0,0] neg_hi:[0,0,0]
    v_pk_fma_f32 v[8:9], v[192:193], v[14:15], v[142:143] op_sel:[1,0,0] op_sel_hi:[1,1,1] neg_lo:[1,0,0] neg_hi:[1,0,0]
    v_pk_fma_f32 v[10:11], v[192:193], v[12:13], v[158:159] op_sel:[1,0,0] op_sel_hi:[1,1,1] neg_lo:[0,0,1] neg_hi:[0,0,1]
    v_pk_fma_f32 v[12:13], v[192:193], v[12:13], v[8:9] op_sel:[0,0,0] op_sel_hi:[0,1,1]
    v_pk_fma_f32 v[14:15], v[192:193], v[14:15], v[10:11] op_sel:[0,0,0] op_sel_hi:[0,1,1] neg_lo:[0,0,0] neg_hi:[0,0,0]
    v_fma_f32 v8, -v195, v14, v13
    v_fma_f32 v10, v195, v12, v15
    v_fma_f32 v16, v194, v12, v8
    v_fma_f32 v17, v194, v14, v10
    ds_write_b64 v220, v[16:17] offset:1024
    ds_write_b32 v254, v255 offset:192
    s_mov_b32 s56, s36
    s_mov_b32 s57, s37
    s_mov_b32 s58, 0x80000
    s_mov_b32 s59, 0x20000
    s_mov_b32 s60, s38
    s_mov_b32 s61, s39
    s_mov_b32 s62, 0x80000
    s_mov_b32 s63, 0x20000
    s_lshl_b32 s12, s72, 1
    s_mov_b32 s76, 0
    s_mov_b32 s77, -1
    s_lshl_b32 s13, s7, 14
    s_lshl_b32 s10, s6, 9
    s_add_u32 s13, s13, s10
    s_add_u32 s13, s13, 0x40000
    s_mov_b32 s15, 400000
W_19:
    ds_read_b32 v249, v253 offset:192
    s_waitcnt lgkmcnt(0)
    v_cmp_eq_u32 vcc, 0, v249
    s_nop 0
    s_cbranch_vccz WD_20
    s_sleep 1
    s_sub_u32 s15, s15, 1
    s_cbranch_scc0 W_19
WD_20:
    ds_read_b64 v[20:21], v227 offset:1024
    ds_read_b64 v[22:23], v227 offset:1280
    ds_read_b64 v[24:25], v227 offset:17664
    ds_read_b64 v[26:27], v227 offset:17920
    ds_read_b64 v[28:29], v227 offset:34304
    ds_read_b64 v[30:31], v227 offset:34560
    ds_read_b64 v[32:33], v227 offset:50944
    s_waitcnt lgkmcnt(0)
    s_cmp_lt_u32 s12, 0
    s_cbranch_scc1 L_lh_done
    s_cmp_gt_u32 s12, 0
    s_cselect_b64 exec, -1, s[76:77]
    v_pk_fma_f32 v[8:9], v[196:197], v[238:239], v[20:21] op_sel:[0,0,0] op_sel_hi:[0,1,1]
    v_pk_fma_f32 v[238:239], v[196:197], v[238:239], v[8:9] op_sel:[1,1,0] op_sel_hi:[1,0,1] neg_lo:[1,0,0]
    s_cmp_lt_u32 s12, 1
    s_cbranch_scc1 L_lh_done
    s_cmp_gt_u32 s12, 1
    s_cselect_b64 exec, -1, s[76:77]
    v_pk_fma_f32 v[8:9], v[196:197], v[238:239], v[22:23] op_sel:[0,0,0] op_sel_hi:[0,1,1]
    v_pk_fma_f32 v[238:239], v[196:197], v[238:239], v[8:9] op_sel:[1,1,0] op_sel_hi:[1,0,1] neg_lo:[1,0,0]
    s_cmp_lt_u32 s12, 2
    s_cbranch_scc1 L_lh_done
    s_cmp_gt_u32 s12, 2
    s_cselect_b64 exec, -1, s[76:77]
    v_pk_fma_f32 v[8:9], v[196:197], v[238:239], v[24:25] op_sel:[0,0,0] op_sel_hi:[0,1,1]
    v_pk_fma_f32 v[238:239], v[196:197], v[238:239], v[8:9] op_sel:[1,1,0] op_sel_hi:[1,0,1] neg_lo:[1,0,0]
    s_cmp_lt_u32 s12, 3
    s_cbranch_scc1 L_lh_done
    s_cmp_gt_u32 s12, 3
    s_cselect_b64 exec, -1, s[76:77]
    v_pk_fma_f32 v[8:9], v[196:197], v[238:239], v[26:27] op_sel:[0,0,0] op_sel_hi:[0,1,1]
    v_pk_fma_f32 v[238:239], v[196:197], v[238:239], v[8:9] op_sel:[1,1,0] op_sel_hi:[1,0,1] neg_lo:[1,0,0]
    s_cmp_lt_u32 s12, 4
    s_cbranch_scc1 L_lh_done
    s_cmp_gt_u32 s12, 4
    s_cselect_b64 exec, -1, s[76:77]
    v_pk_fma_f32 v[8:9], v[196:197], v[238:239], v[28:29] op_sel:[0,0,0] op_sel_hi:[0,1,1]
    v_pk_fma_f32 v[238:239], v[196:197], v[238:239], v[8:9] op_sel:[1,1,0] op_sel_hi:[1,0,1] neg_lo:[1,0,0]
    s_cmp_lt_u32 s12, 5
    s_cbranch_scc1 L_lh_done
    s_cmp_gt_u32 s12, 5
    s_cselect_b64 exec, -1, s[76:77]
    v_pk_fma_f32 v[8:9], v[196:197], v[238:239], v[30:31] op_sel:[0,0,0] op_sel_hi:[0,1,1]
    v_pk_fma_f32 v[238:239], v[196:197], v[238:239], v[8:9] op_sel:[1,1,0] op_sel_hi:[1,0,1] neg_lo:[1,0,0]
    s_cmp_lt_u32 s12, 6
    s_cbranch_scc1 L_lh_done
    s_cmp_gt_u32 s12, 6
    s_cselect_b64 exec, -1, s[76:77]
    v_pk_fma_f32 v[8:9], v[196:197], v[238:239], v[32:33] op_sel:[0,0,0] op_sel_hi:[0,1,1]
    v_pk_fma_f32 v[238:239], v[196:197], v[238:239], v[8:9] op_sel:[1,1,0] op_sel_hi:[1,0,1] neg_lo:[1,0,0]
    v_pk_fma_f32 v[8:9], v[196:197], v[238:239], v[16:17] op_sel:[0,0,0] op_sel_hi:[0,1,1]
    v_pk_fma_f32 v[234:235], v[196:197], v[238:239], v[8:9] op_sel:[1,1,0] op_sel_hi:[1,0,1] neg_lo:[1,0,0]
    s_add_u32 s9, s13, 7680
    buffer_store_dwordx4 v[234:237], v251, s[64:67], s9 offen sc1
L_lh_done:
    s_mov_b64 exec, -1
    v_pk_mul_f32 v[8:9], v[204:205], v[144:145] op_sel:[1,0] op_sel_hi:[1,1]
    v_pk_mul_f32 v[10:11], v[204:205], v[128:129] op_sel:[1,0] op_sel_hi:[1,1]
    v_pk_fma_f32 v[128:129], v[204:205], v[128:129], v[8:9] op_sel:[0,0,0] op_sel_hi:[0,1,1] neg_lo:[0,0,1] neg_hi:[0,0,1]
    v_pk_fma_f32 v[144:145], v[204:205], v[144:145], v[10:11] op_sel:[0,0,0] op_sel_hi:[0,1,1] neg_lo:[1,0,1] neg_hi:[1,0,1]
    v_pk_mul_f32 v[8:9], v[204:205], v[146:147] op_sel:[1,0] op_sel_hi:[1,1]
    v_pk_mul_f32 v[10:11], v[204:205], v[130:131] op_sel:[1,0] op_sel_hi:[1,1]
    v_pk_fma_f32 v[130:131], v[204:205], v[130:131], v[8:9] op_sel:[0,0,0] op_sel_hi:[0,1,1] neg_lo:[0,0,1] neg_hi:[0,0,1]
    v_pk_fma_f32 v[146:147], v[204:205], v[146:147], v[10:11] op_sel:[0,0,0] op_sel_hi:[0,1,1] neg_lo:[1,0,1] neg_hi:[1,0,1]
    v_pk_mul_f32 v[8:9], v[204:205], v[148:149] op_sel:[1,0] op_sel_hi:[1,1]
    v_pk_mul_f32 v[10:11], v[204:205], v[132:133] op_sel:[1,0] op_sel_hi:[1,1]
    v_pk_fma_f32 v[132:133], v[204:205], v[132:133], v[8:9] op_sel:[0,0,0] op_sel_hi:[0,1,1] neg_lo:[0,0,1] neg_hi:[0,0,1]
    v_pk_fma_f32 v[148:149], v[204:205], v[148:149], v[10:11] op_sel:[0,0,0] op_sel_hi:[0,1,1] neg_lo:[1,0,1] neg_hi:[1,0,1]
    v_pk_mul_f32 v[8:9], v[204:205], v[150:151] op_sel:[1,0] op_sel_hi:[1,1]
    v_pk_mul_f32 v[10:11], v[204:205], v[134:135] op_sel:[1,0] op_sel_hi:[1,1]
    v_pk_fma_f32 v[134:135], v[204:205], v[134:135], v[8:9] op_sel:[0,0,0] op_sel_hi:[0,1,1] neg_lo:[0,0,1] neg_hi:[0,0,1]
    v_pk_fma_f32 v[150:151], v[204:205], v[150:151], v[10:11] op_sel:[0,0,0] op_sel_hi:[0,1,1] neg_lo:[1,0,1] neg_hi:[1,0,1]
    v_pk_mul_f32 v[8:9], v[204:205], v[152:153] op_sel:[1,0] op_sel_hi:[1,1]
    v_pk_mul_f32 v[10:11], v[204:205], v[136:137] op_sel:[1,0] op_sel_hi:[1,1]
    v_pk_fma_f32 v[136:137], v[204:205], v[136:137], v[8:9] op_sel:[0,0,0] op_sel_hi:[0,1,1] neg_lo:[0,0,1] neg_hi:[0,0,1]
    v_pk_fma_f32 v[152:153], v[204:205], v[152:153], v[10:11] op_sel:[0,0,0] op_sel_hi:[0,1,1] neg_lo:[1,0,1] neg_hi:[1,0,1]
    v_pk_mul_f32 v[8:9], v[204:205], v[154:155] op_sel:[1,0] op_sel_hi:[1,1]
    v_pk_mul_f32 v[10:11], v[204:205], v[138:139] op_sel:[1,0] op_sel_hi:[1,1]
    v_pk_fma_f32 v[138:139], v[204:205], v[138:139], v[8:9] op_sel:[0,0,0] op_sel_hi:[0,1,1] neg_lo:[0,0,1] neg_hi:[0,0,1]
    v_pk_fma_f32 v[154:155], v[204:205], v[154:155], v[10:11] op_sel:[0,0,0] op_sel_hi:[0,1,1] neg_lo:[1,0,1] neg_hi:[1,0,1]
    v_pk_mul_f32 v[8:9], v[204:205], v[156:157] op_sel:[1,0] op_sel_hi:[1,1]
    v_pk_mul_f32 v[10:11], v[204:205], v[140:141] op_sel:[1,0] op_sel_hi:[1,1]
    v_pk_fma_f32 v[140:141], v[204:205], v[140:141], v[8:9] op_sel:[0,0,0] op_sel_hi:[0,1,1] neg_lo:[0,0,1] neg_hi:[0,0,1]
    v_pk_fma_f32 v[156:157], v[204:205], v[156:157], v[10:11] op_sel:[0,0,0] op_sel_hi:[0,1,1] neg_lo:[1,0,1] neg_hi:[1,0,1]
    v_pk_mul_f32 v[8:9], v[204:205], v[158:159] op_sel:[1,0] op_sel_hi:[1,1]
    v_pk_mul_f32 v[10:11], v[204:205], v[142:143] op_sel:[1,0] op_sel_hi:[1,1]
    v_pk_fma_f32 v[142:143], v[204:205], v[142:143], v[8:9] op_sel:[0,0,0] op_sel_hi:[0,1,1] neg_lo:[0,0,1] neg_hi:[0,0,1]
    v_pk_fma_f32 v[158:159], v[204:205], v[158:159], v[10:11] op_sel:[0,0,0] op_sel_hi:[0,1,1] neg_lo:[1,0,1] neg_hi:[1,0,1]
    s_mul_i32 s10, s72, 16640
    s_lshl_b32 s11, s5, 16
    s_lshl_b32 s12, s72, 14
    s_add_u32 s11, s11, s12
    s_add_u32 m0, s10, 29696
    s_add_u32 s9, s11, 0
    buffer_load_dwordx4 v246, s[56:59], s9 offen offset:0 lds
    s_add_u32 m0, m0, 16
    s_nop 0
    buffer_load_dwordx4 v246, s[56:59], s9 offen offset:1024 lds
    s_add_u32 m0, m0, 16
    s_nop 0
    buffer_load_dwordx4 v246, s[56:59], s9 offen offset:2048 lds
    s_add_u32 m0, m0, 16
    s_nop 0
    buffer_load_dwordx4 v246, s[56:59], s9 offen offset:3072 lds
    s_add_u32 m0, s10, 33856
    s_add_u32 s9, s11, 4096
    buffer_load_dwordx4 v246, s[56:59], s9 offen offset:0 lds
    s_add_u32 m0, m0, 16
    s_nop 0
    buffer_load_dwordx4 v246, s[56:59], s9 offen offset:1024 lds
    s_add_u32 m0, m0, 16
    s_nop 0
    buffer_load_dwordx4 v246, s[56:59], s9 offen offset:2048 lds
    s_add_u32 m0, m0, 16
    s_nop 0
    buffer_load_dwordx4 v246, s[56:59], s9 offen offset:3072 lds
    s_add_u32 m0, s10, 38016
    s_add_u32 s9, s11, 8192
    buffer_load_dwordx4 v246, s[56:59], s9 offen offset:0 lds
    s_add_u32 m0, m0, 16
    s_nop 0
    buffer_load_dwordx4 v246, s[56:59], s9 offen offset:1024 lds
    s_add_u32 m0, m0, 16
    s_nop 0
    buffer_load_dwordx4 v246, s[56:59], s9 offen offset:2048 lds
    s_add_u32 m0, m0, 16
    s_nop 0
    buffer_load_dwordx4 v246, s[56:59], s9 offen offset:3072 lds
    s_add_u32 m0, s10, 42176
    s_add_u32 s9, s11, 12288
    buffer_load_dwordx4 v246, s[56:59], s9 offen offset:0 lds
    s_add_u32 m0, m0, 16
    s_nop 0
    buffer_load_dwordx4 v246, s[56:59], s9 offen offset:1024 lds
    s_add_u32 m0, m0, 16
    s_nop 0
    buffer_load_dwordx4 v246, s[56:59], s9 offen offset:2048 lds
    s_add_u32 m0, m0, 16
    s_nop 0
    buffer_load_dwordx4 v246, s[56:59], s9 offen offset:3072 lds
    s_mov_b32 s15, 100000
L_eg:
    buffer_load_dwordx3 v[24:26], v223, s[64:67], s13 offen offset:0 sc1
    buffer_load_dwordx3 v[28:30], v223, s[64:67], s13 offen offset:512 sc1
    buffer_load_dwordx3 v[32:34], v223, s[64:67], s13 offen offset:1024 sc1
    buffer_load_dwordx3 v[36:38], v223, s[64:67], s13 offen offset:1536 sc1
    buffer_load_dwordx3 v[40:42], v223, s[64:67], s13 offen offset:2048 sc1
    buffer_load_dwordx3 v[44:46], v223, s[64:67], s13 offen offset:2560 sc1
    buffer_load_dwordx3 v[48:50], v223, s[64:67], s13 offen offset:3072 sc1
    buffer_load_dwordx3 v[52:54], v223, s[64:67], s13 offen offset:3584 sc1
    s_waitcnt vmcnt(0)
    v_cmp_ne_u32 vcc, s8, v26
    v_cmp_ne_u32 s[78:79], s8, v30
    s_nop 0
    s_or_b64 vcc, vcc, s[78:79]
    v_cmp_ne_u32 s[78:79], s8, v34
    s_nop 0
    s_or_b64 vcc, vcc, s[78:79]
    v_cmp_ne_u32 s[78:79], s8, v38
    s_nop 0
    s_or_b64 vcc, vcc, s[78:79]
    v_cmp_ne_u32 s[78:79], s8, v42
    s_nop 0
    s_or_b64 vcc, vcc, s[78:79]
    v_cmp_ne_u32 s[78:79], s8, v46
    s_nop 0
    s_or_b64 vcc, vcc, s[78:79]
    v_cmp_ne_u32 s[78:79], s8, v50
    s_nop 0
    s_or_b64 vcc, vcc, s[78:79]
    v_cmp_ne_u32 s[78:79], s8, v54
    s_nop 0
    s_or_b64 vcc, vcc, s[78:79]
    s_cbranch_scc0 L_egd
    s_sleep 10
    s_sub_u32 s15, s15, 1
    s_cbranch_scc0 L_eg
L_egd:
    ds_write_b32 v254, v255 offset:288
    v_pk_fma_f32 v[8:9], v[198:199], v[24:25], v[28:29] op_sel:[0,0,0] op_sel_hi:[0,1,1]
    v_pk_fma_f32 v[24:25], v[198:199], v[24:25], v[8:9] op_sel:[1,1,0] op_sel_hi:[1,0,1] neg_lo:[1,0,0]
    v_pk_fma_f32 v[8:9], v[198:199], v[24:25], v[32:33] op_sel:[0,0,0] op_sel_hi:[0,1,1]
    v_pk_fma_f32 v[24:25], v[198:199], v[24:25], v[8:9] op_sel:[1,1,0] op_sel_hi:[1,0,1] neg_lo:[1,0,0]
    v_pk_fma_f32 v[8:9], v[198:199], v[24:25], v[36:37] op_sel:[0,0,0] op_sel_hi:[0,1,1]
    v_pk_fma_f32 v[24:25], v[198:199], v[24:25], v[8:9] op_sel:[1,1,0] op_sel_hi:[1,0,1] neg_lo:[1,0,0]
    v_pk_fma_f32 v[8:9], v[198:199], v[24:25], v[40:41] op_sel:[0,0,0] op_sel_hi:[0,1,1]
    v_pk_fma_f32 v[24:25], v[198:199], v[24:25], v[8:9] op_sel:[1,1,0] op_sel_hi:[1,0,1] neg_lo:[1,0,0]
    v_pk_fma_f32 v[8:9], v[198:199], v[24:25], v[44:45] op_sel:[0,0,0] op_sel_hi:[0,1,1]
    v_pk_fma_f32 v[24:25], v[198:199], v[24:25], v[8:9] op_sel:[1,1,0] op_sel_hi:[1,0,1] neg_lo:[1,0,0]
    v_pk_fma_f32 v[8:9], v[198:199], v[24:25], v[48:49] op_sel:[0,0,0] op_sel_hi:[0,1,1]
    v_pk_fma_f32 v[24:25], v[198:199], v[24:25], v[8:9] op_sel:[1,1,0] op_sel_hi:[1,0,1] neg_lo:[1,0,0]
    v_pk_fma_f32 v[8:9], v[198:199], v[24:25], v[52:53] op_sel:[0,0,0] op_sel_hi:[0,1,1]
    v_pk_fma_f32 v[24:25], v[198:199], v[24:25], v[8:9] op_sel:[1,1,0] op_sel_hi:[1,0,1] neg_lo:[1,0,0]
    v_pk_mul_f32 v[8:9], v[200:201], v[24:25] op_sel:[0,0] op_sel_hi:[0,1]
    v_pk_fma_f32 v[20:21], v[200:201], v[24:25], v[8:9] op_sel:[1,1,0] op_sel_hi:[1,0,1] neg_lo:[1,0,0]
    v_mov_b32 v22, v20
    v_mov_b32 v23, v21
    s_nop 0
    v_permlane32_swap_b32 v20, v22
    v_permlane32_swap_b32 v21, v23
    v_pk_add_f32 v[20:21], v[20:21], v[22:23]
    v_fma_f32 v8, -v203, v21, v238
    v_fma_f32 v10, v203, v20, v239
    v_fma_f32 v24, v202, v20, v8
    v_fma_f32 v26, v202, v21, v10
    v_fma_f32 v8, -v195, v26, v12
    v_fma_f32 v10, v195, v24, v14
    v_fma_f32 v25, v194, v24, v8
    v_fma_f32 v27, v194, v26, v10
    v_pk_mul_f32 v[8:9], v[204:205], v[26:27] op_sel:[1,0] op_sel_hi:[1,1]
    v_pk_mul_f32 v[10:11], v[204:205], v[24:25] op_sel:[1,0] op_sel_hi:[1,1]
    v_pk_fma_f32 v[24:25], v[204:205], v[24:25], v[8:9] op_sel:[0,0,0] op_sel_hi:[0,1,1] neg_lo:[0,0,0] neg_hi:[0,0,0]
    v_pk_fma_f32 v[26:27], v[204:205], v[26:27], v[10:11] op_sel:[0,0,0] op_sel_hi:[0,1,1] neg_lo:[0,0,1] neg_hi:[0,0,1]
    v_pk_fma_f32 v[8:9], v[192:193], v[26:27], v[128:129] op_sel:[1,0,0] op_sel_hi:[1,1,1] neg_lo:[1,0,0] neg_hi:[1,0,0]
    v_pk_fma_f32 v[10:11], v[192:193], v[24:25], v[144:145] op_sel:[1,0,0] op_sel_hi:[1,1,1] neg_lo:[0,0,0] neg_hi:[0,0,0]
    v_pk_fma_f32 v[128:129], v[192:193], v[24:25], v[8:9] op_sel:[0,0,0] op_sel_hi:[0,1,1]
    v_pk_fma_f32 v[144:145], v[192:193], v[26:27], v[10:11] op_sel:[0,0,0] op_sel_hi:[0,1,1] neg_lo:[0,0,0] neg_hi:[0,0,0]
    v_pk_fma_f32 v[8:9], v[192:193], v[144:145], v[130:131] op_sel:[1,0,0] op_sel_hi:[1,1,1] neg_lo:[1,0,0] neg_hi:[1,0,0]
    v_pk_fma_f32 v[10:11], v[192:193], v[128:129], v[146:147] op_sel:[1,0,0] op_sel_hi:[1,1,1] neg_lo:[0,0,0] neg_hi:[0,0,0]
    v_pk_fma_f32 v[130:131], v[192:193], v[128:129], v[8:9] op_sel:[0,0,0] op_sel_hi:[0,1,1]
    v_pk_fma_f32 v[146:147], v[192:193], v[144:145], v[10:11] op_sel:[0,0,0] op_sel_hi:[0,1,1] neg_lo:[0,0,0] neg_hi:[0,0,0]
    v_pk_fma_f32 v[8:9], v[192:193], v[146:147], v[132:133] op_sel:[1,0,0] op_sel_hi:[1,1,1] neg_lo:[1,0,0] neg_hi:[1,0,0]
    v_pk_fma_f32 v[10:11], v[192:193], v[130:131], v[148:149] op_sel:[1,0,0] op_sel_hi:[1,1,1] neg_lo:[0,0,0] neg_hi:[0,0,0]
    v_pk_fma_f32 v[132:133], v[192:193], v[130:131], v[8:9] op_sel:[0,0,0] op_sel_hi:[0,1,1]
    v_pk_fma_f32 v[148:149], v[192:193], v[146:147], v[10:11] op_sel:[0,0,0] op_sel_hi:[0,1,1] neg_lo:[0,0,0] neg_hi:[0,0,0]
    v_pk_fma_f32 v[8:9], v[192:193], v[148:149], v[134:135] op_sel:[1,0,0] op_sel_hi:[1,1,1] neg_lo:[1,0,0] neg_hi:[1,0,0]
    v_pk_fma_f32 v[10:11], v[192:193], v[132:133], v[150:151] op_sel:[1,0,0] op_sel_hi:[1,1,1] neg_lo:[0,0,0] neg_hi:[0,0,0]
    v_pk_fma_f32 v[134:135], v[192:193], v[132:133], v[8:9] op_sel:[0,0,0] op_sel_hi:[0,1,1]
    v_pk_fma_f32 v[150:151], v[192:193], v[148:149], v[10:11] op_sel:[0,0,0] op_sel_hi:[0,1,1] neg_lo:[0,0,0] neg_hi:[0,0,0]
    v_pk_fma_f32 v[8:9], v[192:193], v[150:151], v[136:137] op_sel:[1,0,0] op_sel_hi:[1,1,1] neg_lo:[1,0,0] neg_hi:[1,0,0]
    v_pk_fma_f32 v[10:11], v[192:193], v[134:135], v[152:153] op_sel:[1,0,0] op_sel_hi:[1,1,1] neg_lo:[0,0,0] neg_hi:[0,0,0]
    v_pk_fma_f32 v[136:137], v[192:193], v[134:135], v[8:9] op_sel:[0,0,0] op_sel_hi:[0,1,1]
    v_pk_fma_f32 v[152:153], v[192:193], v[150:151], v[10:11] op_sel:[0,0,0] op_sel_hi:[0,1,1] neg_lo:[0,0,0] neg_hi:[0,0,0]
    v_pk_fma_f32 v[8:9], v[192:193], v[152:153], v[138:139] op_sel:[1,0,0] op_sel_hi:[1,1,1] neg_lo:[1,0,0] neg_hi:[1,0,0]
    v_pk_fma_f32 v[10:11], v[192:193], v[136:137], v[154:155] op_sel:[1,0,0] op_sel_hi:[1,1,1] neg_lo:[0,0,0] neg_hi:[0,0,0]
    v_pk_fma_f32 v[138:139], v[192:193], v[136:137], v[8:9] op_sel:[0,0,0] op_sel_hi:[0,1,1]
    v_pk_fma_f32 v[154:155], v[192:193], v[152:153], v[10:11] op_sel:[0,0,0] op_sel_hi:[0,1,1] neg_lo:[0,0,0] neg_hi:[0,0,0]
    v_pk_fma_f32 v[8:9], v[192:193], v[154:155], v[140:141] op_sel:[1,0,0] op_sel_hi:[1,1,1] neg_lo:[1,0,0] neg_hi:[1,0,0]
    v_pk_fma_f32 v[10:11], v[192:193], v[138:139], v[156:157] op_sel:[1,0,0] op_sel_hi:[1,1,1] neg_lo:[0,0,0] neg_hi:[0,0,0]
    v_pk_fma_f32 v[140:141], v[192:193], v[138:139], v[8:9] op_sel:[0,0,0] op_sel_hi:[0,1,1]
    v_pk_fma_f32 v[156:157], v[192:193], v[154:155], v[10:11] op_sel:[0,0,0] op_sel_hi:[0,1,1] neg_lo:[0,0,0] neg_hi:[0,0,0]
    v_pk_fma_f32 v[8:9], v[192:193], v[156:157], v[142:143] op_sel:[1,0,0] op_sel_hi:[1,1,1] neg_lo:[1,0,0] neg_hi:[1,0,0]
    v_pk_fma_f32 v[10:11], v[192:193], v[140:141], v[158:159] op_sel:[1,0,0] op_sel_hi:[1,1,1] neg_lo:[0,0,0] neg_hi:[0,0,0]
    v_pk_fma_f32 v[142:143], v[192:193], v[140:141], v[8:9] op_sel:[0,0,0] op_sel_hi:[0,1,1]
    v_pk_fma_f32 v[158:159], v[192:193], v[156:157], v[10:11] op_sel:[0,0,0] op_sel_hi:[0,1,1] neg_lo:[0,0,0] neg_hi:[0,0,0]
    v_cvt_pk_bf16_f32 v28, v128, v130
    v_cvt_pk_bf16_f32 v29, v132, v134
    v_cvt_pk_bf16_f32 v30, v136, v138
    v_cvt_pk_bf16_f32 v31, v140, v142
    v_cvt_pk_bf16_f32 v32, v129, v131
    v_cvt_pk_bf16_f32 v33, v133, v135
    v_cvt_pk_bf16_f32 v34, v137, v139
    v_cvt_pk_bf16_f32 v35, v141, v143
    ds_write_b128 v221, v[28:31] offset:2048
    ds_write_b128 v221, v[32:35] offset:2064
    v_cvt_pk_bf16_f32 v36, v144, v146
    v_cvt_pk_bf16_f32 v37, v148, v150
    v_cvt_pk_bf16_f32 v38, v152, v154
    v_cvt_pk_bf16_f32 v39, v156, v158
    v_cvt_pk_bf16_f32 v40, v145, v147
    v_cvt_pk_bf16_f32 v41, v149, v151
    v_cvt_pk_bf16_f32 v42, v153, v155
    v_cvt_pk_bf16_f32 v43, v157, v159
    ds_write_b128 v221, v[36:39] offset:4096
    ds_write_b128 v221, v[40:43] offset:4112
    ds_read_b64_tr_b16 v[44:45], v222 offset:2048
    ds_read_b64_tr_b16 v[46:47], v222 offset:2304
    ds_read_b64_tr_b16 v[48:49], v222 offset:3072
    ds_read_b64_tr_b16 v[50:51], v222 offset:3328
    ds_read_b64_tr_b16 v[52:53], v222 offset:4096
    ds_read_b64_tr_b16 v[54:55], v222 offset:4352
    ds_read_b64_tr_b16 v[56:57], v222 offset:5120
    ds_read_b64_tr_b16 v[58:59], v222 offset:5376
    s_lshl_b32 s9, s73, 1
    s_lshl_b32 s10, s7, 11
    s_add_u32 s9, s9, s10
    s_add_u32 s9, s9, 0x400000
    s_add_u32 s10, s9, 0x8000
    s_waitcnt lgkmcnt(6)
    buffer_store_dwordx4 v[44:47], v251, s[64:67], s9 offen offset:0 sc1
    s_waitcnt lgkmcnt(4)
    buffer_store_dwordx4 v[48:51], v251, s[64:67], s9 offen offset:1024 sc1
    s_waitcnt lgkmcnt(2)
    buffer_store_dwordx4 v[52:55], v251, s[64:67], s10 offen offset:0 sc1
    s_waitcnt lgkmcnt(0)
    buffer_store_dwordx4 v[56:59], v251, s[64:67], s10 offen offset:1024 sc1
    s_lshl_b32 s9, s75, 15
    s_lshl_b32 s10, s80, 6
    s_add_u32 s9, s9, s10
    buffer_load_dwordx4 v[184:187], v224, s[52:55], s9 offen
    buffer_load_dwordx4 v[188:191], v224, s[52:55], s9 offen offset:32
    s_lshr_b32 s13, s73, 4
    s_lshl_b32 s12, s7, 7
    s_add_u32 s13, s13, s12
    s_add_u32 s13, s13, 0x80000
    s_mov_b32 s15, 400000
W_21:
    ds_read_b32 v249, v253 offset:288
    s_waitcnt lgkmcnt(0)
    v_cmp_eq_u32 vcc, 0, v249
    s_nop 0
    s_cbranch_vccz WD_22
    s_sleep 1
    s_sub_u32 s15, s15, 1
    s_cbranch_scc0 W_21
WD_22:
    ds_read_b128 v[0:3], v228 offset:0
    ds_read_b128 v[4:7], v229 offset:0
    ds_read_b128 v[8:11], v228 offset:32
    ds_read_b128 v[12:15], v229 offset:32
    ds_read_b128 v[16:19], v228 offset:64
    ds_read_b128 v[20:23], v229 offset:64
    ds_read_b128 v[24:27], v228 offset:96
    ds_read_b128 v[28:31], v229 offset:96
    ds_read_b128 v[32:35], v228 offset:128
    ds_read_b128 v[36:39], v229 offset:128
    ds_read_b128 v[40:43], v228 offset:160
    ds_read_b128 v[44:47], v229 offset:160
    ds_read_b128 v[48:51], v228 offset:192
    ds_read_b128 v[52:55], v229 offset:192
    ds_read_b128 v[56:59], v228 offset:224
    ds_read_b128 v[60:63], v229 offset:224
    ds_read_b128 v[64:67], v228 offset:256
    ds_read_b128 v[68:71], v229 offset:256
    ds_read_b128 v[72:75], v228 offset:288
    ds_read_b128 v[76:79], v229 offset:288
    ds_read_b128 v[80:83], v228 offset:320
    ds_read_b128 v[84:87], v229 offset:320
    ds_read_b128 v[88:91], v228 offset:352
    ds_read_b128 v[92:95], v229 offset:352
    ds_read_b128 v[96:99], v228 offset:384
    ds_read_b128 v[100:103], v229 offset:384
    ds_read_b128 v[104:107], v228 offset:416
    ds_read_b128 v[108:111], v229 offset:416
    ds_read_b128 v[112:115], v228 offset:448
    ds_read_b128 v[116:119], v229 offset:448
    ds_read_b128 v[120:123], v228 offset:480
    ds_read_b128 v[124:127], v229 offset:480
    ds_write_b32 v254, v255 offset:240
    s_mov_b32 s78, -1
    s_mov_b32 s79, 0
    s_waitcnt vmcnt(2)
    s_mov_b64 exec, s[78:79]
    buffer_store_dword v236, v225, s[64:67], s13 offen sc1
    s_mov_b64 exec, -1
    s_waitcnt vmcnt(1)
    v_mfma_f32_32x32x16_bf16 v[128:143], v[184:187], v[206:209], 0
    v_mfma_f32_32x32x16_bf16 v[128:143], v[188:191], v[210:213], v[128:143]
    s_mov_b32 s56, s24
    s_mov_b32 s57, s25
    s_mov_b32 s58, 0x80000
    s_mov_b32 s59, 0x20000
    s_lshl_b32 s13, s72, 17
    s_lshl_b32 s10, s5, 7
    s_add_u32 s13, s13, s10
    s_and_b32 s10, s5, 3
    s_lshl_b32 s10, s10, 16
    s_xor_b32 s13, s13, s10
    s_lshl_b32 s10, s72, 14
    s_add_u32 m0, s10, 29696
    s_mov_b32 s15, 400000
W_23:
    ds_read_b32 v249, v253 offset:240
    s_waitcnt lgkmcnt(0)
    v_cmp_eq_u32 vcc, 0, v249
    s_nop 0
    s_cbranch_vccz WD_24
    s_sleep 1
    s_sub_u32 s15, s15, 1
    s_cbranch_scc0 W_23
WD_24:
    s_xor_b32 s9, s13, 0x0
    buffer_load_dwordx4 v226, s[56:59], s9 offen lds
    s_add_u32 m0, m0, 1024
    s_xor_b32 s9, s13, 0x2000
    buffer_load_dwordx4 v226, s[56:59], s9 offen lds
    s_add_u32 m0, m0, 1024
    s_xor_b32 s9, s13, 0x4000
    buffer_load_dwordx4 v226, s[56:59], s9 offen lds
    s_add_u32 m0, m0, 1024
    s_xor_b32 s9, s13, 0x6000
    buffer_load_dwordx4 v226, s[56:59], s9 offen lds
    s_add_u32 m0, m0, 1024
    s_xor_b32 s9, s13, 0x8000
    buffer_load_dwordx4 v226, s[56:59], s9 offen lds
    s_add_u32 m0, m0, 1024
    s_xor_b32 s9, s13, 0xa000
    buffer_load_dwordx4 v226, s[56:59], s9 offen lds
    s_add_u32 m0, m0, 1024
    s_xor_b32 s9, s13, 0xc000
    buffer_load_dwordx4 v226, s[56:59], s9 offen lds
    s_add_u32 m0, m0, 1024
    s_xor_b32 s9, s13, 0xe000
    buffer_load_dwordx4 v226, s[56:59], s9 offen lds
    s_add_u32 m0, m0, 1024
    s_xor_b32 s9, s13, 0x10000
    buffer_load_dwordx4 v226, s[56:59], s9 offen lds
    s_add_u32 m0, m0, 1024
    s_xor_b32 s9, s13, 0x12000
    buffer_load_dwordx4 v226, s[56:59], s9 offen lds
    s_add_u32 m0, m0, 1024
    s_xor_b32 s9, s13, 0x14000
    buffer_load_dwordx4 v226, s[56:59], s9 offen lds
    s_add_u32 m0, m0, 1024
    s_xor_b32 s9, s13, 0x16000
    buffer_load_dwordx4 v226, s[56:59], s9 offen lds
    s_add_u32 m0, m0, 1024
    s_xor_b32 s9, s13, 0x18000
    buffer_load_dwordx4 v226, s[56:59], s9 offen lds
    s_add_u32 m0, m0, 1024
    s_xor_b32 s9, s13, 0x1a000
    buffer_load_dwordx4 v226, s[56:59], s9 offen lds
    s_add_u32 m0, m0, 1024
    s_xor_b32 s9, s13, 0x1c000
    buffer_load_dwordx4 v226, s[56:59], s9 offen lds
    s_add_u32 m0, m0, 1024
    s_xor_b32 s9, s13, 0x1e000
    buffer_load_dwordx4 v226, s[56:59], s9 offen lds
    s_add_u32 m0, m0, 1024
    s_lshl_b32 s9, s75, 11
    s_add_u32 s9, s9, 0x80000
    s_mov_b64 exec, 0xffff
    s_mov_b32 s15, 100000
L_gph:
    buffer_load_dword v249, v232, s[64:67], s9 offen sc1
    s_waitcnt vmcnt(0)
    v_cmp_ne_u32 vcc, s8, v249
    s_nop 0
    s_cbranch_vccz L_gdh
    s_sleep 10
    s_sub_u32 s15, s15, 1
    s_cbranch_scc0 L_gph
L_gdh:
    s_mov_b64 exec, -1
    ds_write_b32 v254, v255 offset:224
    s_lshl_b32 s12, s75, 16
    s_and_b32 s9, s72, 1
    s_lshl_b32 s9, s9, 14
    s_add_u32 s12, s12, s9
    s_add_u32 s12, s12, 0x400000
    buffer_load_dwordx4 v[160:163], v251, s[64:67], s12 offen offset:0 sc1
    buffer_load_dwordx4 v[164:167], v251, s[64:67], s12 offen offset:1024 sc1
    buffer_load_dwordx4 v[168:171], v251, s[64:67], s12 offen offset:2048 sc1
    buffer_load_dwordx4 v[172:175], v251, s[64:67], s12 offen offset:3072 sc1
    s_xor_b32 s12, s12, 0x1000
    buffer_load_dwordx4 v[176:179], v251, s[64:67], s12 offen offset:0 sc1
    buffer_load_dwordx4 v[180:183], v251, s[64:67], s12 offen offset:1024 sc1
    buffer_load_dwordx4 v[184:187], v251, s[64:67], s12 offen offset:2048 sc1
    buffer_load_dwordx4 v[188:191], v251, s[64:67], s12 offen offset:3072 sc1
    s_xor_b32 s12, s12, 0x3000
    buffer_load_dwordx4 v[192:195], v251, s[64:67], s12 offen offset:0 sc1
    buffer_load_dwordx4 v[196:199], v251, s[64:67], s12 offen offset:1024 sc1
    buffer_load_dwordx4 v[200:203], v251, s[64:67], s12 offen offset:2048 sc1
    buffer_load_dwordx4 v[204:207], v251, s[64:67], s12 offen offset:3072 sc1
    s_setprio 0
    s_mul_i32 s10, s72, 16640
    s_lshl_b32 s11, s5, 16
    s_lshl_b32 s13, s72, 14
    s_add_u32 s11, s11, s13
    s_waitcnt vmcnt(11) lgkmcnt(0)
    v_mfma_f32_32x32x16_bf16 v[128:143], v[160:163], v[0:3], v[128:143]
    v_mfma_f32_32x32x16_bf16 v[144:159], v[160:163], v[4:7], 0
    s_add_u32 m0, s10, 96256
    s_add_u32 s9, s11, 0
    buffer_load_dwordx4 v246, s[60:63], s9 offen offset:0 lds
    s_add_u32 m0, m0, 16
    s_nop 0
    buffer_load_dwordx4 v246, s[60:63], s9 offen offset:1024 lds
    s_add_u32 m0, m0, 16
    s_nop 0
    buffer_load_dwordx4 v246, s[60:63], s9 offen offset:2048 lds
    s_add_u32 m0, m0, 16
    s_nop 0
    buffer_load_dwordx4 v246, s[60:63], s9 offen offset:3072 lds
    s_xor_b32 s12, s12, 0x1000
    buffer_load_dwordx4 v[208:211], v251, s[64:67], s12 offen offset:0 sc1
    s_waitcnt vmcnt(15) lgkmcnt(0)
    v_mfma_f32_32x32x16_bf16 v[128:143], v[164:167], v[8:11], v[128:143]
    v_mfma_f32_32x32x16_bf16 v[144:159], v[164:167], v[12:15], v[144:159]
    s_add_u32 m0, s10, 100416
    s_add_u32 s9, s11, 4096
    buffer_load_dwordx4 v246, s[60:63], s9 offen offset:0 lds
    s_add_u32 m0, m0, 16
    s_nop 0
    buffer_load_dwordx4 v246, s[60:63], s9 offen offset:1024 lds
    s_add_u32 m0, m0, 16
    s_nop 0
    buffer_load_dwordx4 v246, s[60:63], s9 offen offset:2048 lds
    s_add_u32 m0, m0, 16
    s_nop 0
    buffer_load_dwordx4 v246, s[60:63], s9 offen offset:3072 lds
    buffer_load_dwordx4 v[160:163], v251, s[64:67], s12 offen offset:1024 sc1
    s_waitcnt vmcnt(19) lgkmcnt(0)
    v_mfma_f32_32x32x16_bf16 v[128:143], v[168:171], v[16:19], v[128:143]
    v_mfma_f32_32x32x16_bf16 v[144:159], v[168:171], v[20:23], v[144:159]
    s_add_u32 m0, s10, 104576
    s_add_u32 s9, s11, 8192
    buffer_load_dwordx4 v246, s[60:63], s9 offen offset:0 lds
    s_add_u32 m0, m0, 16
    s_nop 0
    buffer_load_dwordx4 v246, s[60:63], s9 offen offset:1024 lds
    s_add_u32 m0, m0, 16
    s_nop 0
    buffer_load_dwordx4 v246, s[60:63], s9 offen offset:2048 lds
    s_add_u32 m0, m0, 16
    s_nop 0
    buffer_load_dwordx4 v246, s[60:63], s9 offen offset:3072 lds
    buffer_load_dwordx4 v[164:167], v251, s[64:67], s12 offen offset:2048 sc1
    s_waitcnt vmcnt(23) lgkmcnt(0)
    v_mfma_f32_32x32x16_bf16 v[128:143], v[172:175], v[24:27], v[128:143]
    v_mfma_f32_32x32x16_bf16 v[144:159], v[172:175], v[28:31], v[144:159]
    s_add_u32 m0, s10, 108736
    s_add_u32 s9, s11, 12288
    buffer_load_dwordx4 v246, s[60:63], s9 offen offset:0 lds
    s_add_u32 m0, m0, 16
    s_nop 0
    buffer_load_dwordx4 v246, s[60:63], s9 offen offset:1024 lds
    s_add_u32 m0, m0, 16
    s_nop 0
    buffer_load_dwordx4 v246, s[60:63], s9 offen offset:2048 lds
    s_add_u32 m0, m0, 16
    s_nop 0
    buffer_load_dwordx4 v246, s[60:63], s9 offen offset:3072 lds
    buffer_load_dwordx4 v[168:171], v251, s[64:67], s12 offen offset:3072 sc1
    s_waitcnt vmcnt(27) lgkmcnt(0)
    v_mfma_f32_32x32x16_bf16 v[128:143], v[176:179], v[32:35], v[128:143]
    v_mfma_f32_32x32x16_bf16 v[144:159], v[176:179], v[36:39], v[144:159]
    s_xor_b32 s12, s12, 0xb000
    buffer_load_dwordx4 v[172:175], v251, s[64:67], s12 offen offset:0 sc1
    s_waitcnt vmcnt(27) lgkmcnt(0)
    v_mfma_f32_32x32x16_bf16 v[128:143], v[180:183], v[40:43], v[128:143]
    v_mfma_f32_32x32x16_bf16 v[144:159], v[180:183], v[44:47], v[144:159]
    buffer_load_dwordx4 v[176:179], v251, s[64:67], s12 offen offset:1024 sc1
    s_waitcnt vmcnt(27) lgkmcnt(0)
    v_mfma_f32_32x32x16_bf16 v[128:143], v[184:187], v[48:51], v[128:143]
    v_mfma_f32_32x32x16_bf16 v[144:159], v[184:187], v[52:55], v[144:159]
    buffer_load_dwordx4 v[180:183], v251, s[64:67], s12 offen offset:2048 sc1
    s_waitcnt vmcnt(27) lgkmcnt(0)
    v_mfma_f32_32x32x16_bf16 v[128:143], v[188:191], v[56:59], v[128:143]
    v_mfma_f32_32x32x16_bf16 v[144:159], v[188:191], v[60:63], v[144:159]
    buffer_load_dwordx4 v[184:187], v251, s[64:67], s12 offen offset:3072 sc1
    s_waitcnt vmcnt(27) lgkmcnt(0)
    v_mfma_f32_32x32x16_bf16 v[128:143], v[192:195], v[64:67], v[128:143]
    v_mfma_f32_32x32x16_bf16 v[144:159], v[192:195], v[68:71], v[144:159]
    s_xor_b32 s12, s12, 0x1000
    buffer_load_dwordx4 v[188:191], v251, s[64:67], s12 offen offset:0 sc1
    s_waitcnt vmcnt(27) lgkmcnt(0)
    v_mfma_f32_32x32x16_bf16 v[128:143], v[196:199], v[72:75], v[128:143]
    v_mfma_f32_32x32x16_bf16 v[144:159], v[196:199], v[76:79], v[144:159]
    s_waitcnt vmcnt(6)
    ds_write_b32 v254, v255 offset:304
    buffer_load_dwordx4 v[192:195], v251, s[64:67], s12 offen offset:1024 sc1
    s_waitcnt lgkmcnt(0)
    v_mfma_f32_32x32x16_bf16 v[128:143], v[200:203], v[80:83], v[128:143]
    v_mfma_f32_32x32x16_bf16 v[144:159], v[200:203], v[84:87], v[144:159]
    buffer_load_dwordx4 v[196:199], v251, s[64:67], s12 offen offset:2048 sc1
    s_waitcnt lgkmcnt(0)
    v_mfma_f32_32x32x16_bf16 v[128:143], v[204:207], v[88:91], v[128:143]
    v_mfma_f32_32x32x16_bf16 v[144:159], v[204:207], v[92:95], v[144:159]
    s_setprio 3
    s_mov_b32 s15, 400000
W_25:
    ds_read_b32 v249, v253 offset:304
    s_waitcnt lgkmcnt(0)
    v_cmp_eq_u32 vcc, 0, v249
    s_nop 0
    s_cbranch_vccz WD_26
    s_sleep 1
    s_sub_u32 s15, s15, 1
    s_cbranch_scc0 W_25
WD_26:
    s_setprio 0
    ds_read_b128 v[0:3], v230 offset:0
    ds_read_b128 v[4:7], v231 offset:0
    buffer_load_dwordx4 v[200:203], v251, s[64:67], s12 offen offset:3072 sc1
    s_waitcnt lgkmcnt(0)
    v_mfma_f32_32x32x16_bf16 v[128:143], v[208:211], v[96:99], v[128:143]
    v_mfma_f32_32x32x16_bf16 v[144:159], v[208:211], v[100:103], v[144:159]
    ds_read_b128 v[8:11], v230 offset:32
    ds_read_b128 v[12:15], v231 offset:32
    s_xor_b32 s12, s12, 0x3000
    buffer_load_dwordx4 v[204:207], v251, s[64:67], s12 offen offset:0 sc1
    s_waitcnt lgkmcnt(0)
    v_mfma_f32_32x32x16_bf16 v[128:143], v[160:163], v[104:107], v[128:143]
    v_mfma_f32_32x32x16_bf16 v[144:159], v[160:163], v[108:111], v[144:159]
    ds_read_b128 v[16:19], v230 offset:64
    ds_read_b128 v[20:23], v231 offset:64
    buffer_load_dwordx4 v[208:211], v251, s[64:67], s12 offen offset:1024 sc1
    s_waitcnt lgkmcnt(0)
    v_mfma_f32_32x32x16_bf16 v[128:143], v[164:167], v[112:115], v[128:143]
    v_mfma_f32_32x32x16_bf16 v[144:159], v[164:167], v[116:119], v[144:159]
    ds_read_b128 v[24:27], v230 offset:96
    ds_read_b128 v[28:31], v231 offset:96
    buffer_load_dwordx4 v[160:163], v251, s[64:67], s12 offen offset:2048 sc1
    s_waitcnt vmcnt(11) lgkmcnt(0)
    v_mfma_f32_32x32x16_bf16 v[128:143], v[168:171], v[120:123], v[128:143]
    v_mfma_f32_32x32x16_bf16 v[144:159], v[168:171], v[124:127], v[144:159]
    ds_read_b128 v[32:35], v230 offset:128
    ds_read_b128 v[36:39], v231 offset:128
    buffer_load_dwordx4 v[164:167], v251, s[64:67], s12 offen offset:3072 sc1
    s_waitcnt vmcnt(11) lgkmcnt(0)
    v_mfma_f32_32x32x16_bf16 v[128:143], v[172:175], v[0:3], v[128:143]
    v_mfma_f32_32x32x16_bf16 v[144:159], v[172:175], v[4:7], v[144:159]
    ds_read_b128 v[40:43], v230 offset:160
    ds_read_b128 v[44:47], v231 offset:160
    s_xor_b32 s12, s12, 0x1000
    buffer_load_dwordx4 v[168:171], v251, s[64:67], s12 offen offset:0 sc1
    s_waitcnt vmcnt(11) lgkmcnt(0)
    v_mfma_f32_32x32x16_bf16 v[128:143], v[176:179], v[8:11], v[128:143]
    v_mfma_f32_32x32x16_bf16 v[144:159], v[176:179], v[12:15], v[144:159]
    ds_read_b128 v[48:51], v230 offset:192
    ds_read_b128 v[52:55], v231 offset:192
    buffer_load_dwordx4 v[172:175], v251, s[64:67], s12 offen offset:1024 sc1
    s_waitcnt vmcnt(11) lgkmcnt(0)
    v_mfma_f32_32x32x16_bf16 v[128:143], v[180:183], v[16:19], v[128:143]
    v_mfma_f32_32x32x16_bf16 v[144:159], v[180:183], v[20:23], v[144:159]
    ds_read_b128 v[56:59], v230 offset:224
    ds_read_b128 v[60:63], v231 offset:224
    buffer_load_dwordx4 v[176:179], v251, s[64:67], s12 offen offset:2048 sc1
    s_waitcnt vmcnt(11) lgkmcnt(0)
    v_mfma_f32_32x32x16_bf16 v[128:143], v[184:187], v[24:27], v[128:143]
    v_mfma_f32_32x32x16_bf16 v[144:159], v[184:187], v[28:31], v[144:159]
    ds_read_b128 v[64:67], v230 offset:256
    ds_read_b128 v[68:71], v231 offset:256
    buffer_load_dwordx4 v[180:183], v251, s[64:67], s12 offen offset:3072 sc1
    s_setprio 3
    s_mov_b32 s15, 400000
W_27:
    ds_read_b32 v249, v254 offset:112
    s_waitcnt lgkmcnt(0)
    v_cmp_eq_u32 vcc, 0, v249
    s_nop 0
    s_cbranch_vccz WD_28
    s_sleep 4
    s_sub_u32 s15, s15, 1
    s_cbranch_scc0 W_27
WD_28:
    s_setprio 0
    s_waitcnt vmcnt(11) lgkmcnt(0)
    v_mfma_f32_32x32x16_bf16 v[128:143], v[188:191], v[32:35], v[128:143]
    v_mfma_f32_32x32x16_bf16 v[144:159], v[188:191], v[36:39], v[144:159]
    ds_read_b128 v[72:75], v230 offset:288
    ds_read_b128 v[76:79], v231 offset:288
    s_waitcnt vmcnt(10) lgkmcnt(0)
    v_mfma_f32_32x32x16_bf16 v[128:143], v[192:195], v[40:43], v[128:143]
    v_mfma_f32_32x32x16_bf16 v[144:159], v[192:195], v[44:47], v[144:159]
    ds_read_b128 v[80:83], v230 offset:320
    ds_read_b128 v[84:87], v231 offset:320
    s_waitcnt vmcnt(9) lgkmcnt(0)
    v_mfma_f32_32x32x16_bf16 v[128:143], v[196:199], v[48:51], v[128:143]
    v_mfma_f32_32x32x16_bf16 v[144:159], v[196:199], v[52:55], v[144:159]
    ds_read_b128 v[88:91], v230 offset:352
    ds_read_b128 v[92:95], v231 offset:352
    ds_read_b128 v[96:99], v230 offset:384
    ds_read_b128 v[100:103], v231 offset:384
    ds_read_b128 v[104:107], v230 offset:416
    ds_read_b128 v[108:111], v231 offset:416
    ds_read_b128 v[112:115], v230 offset:448
    ds_read_b128 v[116:119], v231 offset:448
    ds_read_b128 v[120:123], v230 offset:480
    ds_read_b128 v[124:127], v231 offset:480
    ds_write_b32 v254, v255 offset:256
    s_waitcnt vmcnt(0) lgkmcnt(0)
    v_mfma_f32_32x32x16_bf16 v[144:159], v[200:203], v[60:63], v[144:159]
    v_mfma_f32_32x32x16_bf16 v[144:159], v[204:207], v[68:71], v[144:159]
    v_mfma_f32_32x32x16_bf16 v[144:159], v[208:211], v[76:79], v[144:159]
    v_mfma_f32_32x32x16_bf16 v[144:159], v[160:163], v[84:87], v[144:159]
    v_mfma_f32_32x32x16_bf16 v[144:159], v[164:167], v[92:95], v[144:159]
    v_mfma_f32_32x32x16_bf16 v[144:159], v[168:171], v[100:103], v[144:159]
    v_mfma_f32_32x32x16_bf16 v[144:159], v[172:175], v[108:111], v[144:159]
    v_mfma_f32_32x32x16_bf16 v[144:159], v[176:179], v[116:119], v[144:159]
    v_mfma_f32_32x32x16_bf16 v[144:159], v[180:183], v[124:127], v[144:159]
    v_mfma_f32_32x32x16_bf16 v[128:143], v[200:203], v[56:59], v[128:143]
    v_mfma_f32_32x32x16_bf16 v[128:143], v[204:207], v[64:67], v[128:143]
    s_setprio 3
    s_mov_b32 s68, s44
    s_mov_b32 s69, s45
    s_mov_b32 s70, 0x800000
    s_mov_b32 s71, 0x20000
    s_lshl_b32 s11, s75, 17
    s_lshl_b32 s10, s80, 7
    s_add_u32 s11, s11, s10
    s_mov_b32 s15, 400000
W_29:
    ds_read_b32 v249, v253 offset:256
    s_waitcnt lgkmcnt(0)
    v_cmp_eq_u32 vcc, 0, v249
    s_nop 0
    s_cbranch_vccz WD_30
    s_sleep 1
    s_sub_u32 s15, s15, 1
    s_cbranch_scc0 W_29
WD_30:
    ds_write_b128 v233, v[144:147] offset:0
    v_mfma_f32_32x32x16_bf16 v[128:143], v[208:211], v[72:75], v[128:143]
    ds_write_b128 v233, v[148:151] offset:1024
    v_mfma_f32_32x32x16_bf16 v[128:143], v[160:163], v[80:83], v[128:143]
    ds_write_b128 v233, v[152:155] offset:2048
    v_mfma_f32_32x32x16_bf16 v[128:143], v[164:167], v[88:91], v[128:143]
    ds_write_b128 v233, v[156:159] offset:3072
    ds_write_b32 v254, v255 offset:272
    v_mfma_f32_32x32x16_bf16 v[128:143], v[168:171], v[96:99], v[128:143]
    v_mfma_f32_32x32x16_bf16 v[128:143], v[172:175], v[104:107], v[128:143]
    v_mfma_f32_32x32x16_bf16 v[128:143], v[176:179], v[112:115], v[128:143]
    v_mfma_f32_32x32x16_bf16 v[128:143], v[180:183], v[120:123], v[128:143]
    s_nop 0
    s_mov_b32 s15, 400000
W_31:
    ds_read_b32 v249, v253 offset:272
    s_waitcnt lgkmcnt(0)
    v_cmp_eq_u32 vcc, 0, v249
    s_nop 0
    s_cbranch_vccz WD_32
    s_sleep 1
    s_sub_u32 s15, s15, 1
    s_cbranch_scc0 W_31
WD_32:
    ds_read_b128 v[144:147], v237 offset:0
    ds_read_b128 v[148:151], v237 offset:1024
    ds_read_b128 v[152:155], v237 offset:2048
    ds_read_b128 v[156:159], v237 offset:3072
    s_waitcnt lgkmcnt(0)
    v_pk_add_f32 v[144:145], v[128:129], v[144:145]
    v_pk_add_f32 v[146:147], v[130:131], v[146:147]
    v_pk_add_f32 v[148:149], v[132:133], v[148:149]
    v_pk_add_f32 v[150:151], v[134:135], v[150:151]
    v_pk_add_f32 v[152:153], v[136:137], v[152:153]
    v_pk_add_f32 v[154:155], v[138:139], v[154:155]
    v_pk_add_f32 v[156:157], v[140:141], v[156:157]
    v_pk_add_f32 v[158:159], v[142:143], v[158:159]
    s_add_u32 s9, s11, 0
    buffer_store_dword v144, v225, s[68:71], s9 offen offset:2048 nt
    s_add_u32 s9, s11, 4096
    buffer_store_dword v145, v225, s[68:71], s9 offen offset:2048 nt
    s_add_u32 s9, s11, 8192
    buffer_store_dword v146, v225, s[68:71], s9 offen offset:2048 nt
    s_add_u32 s9, s11, 12288
    buffer_store_dword v147, v225, s[68:71], s9 offen offset:2048 nt
    s_add_u32 s9, s11, 32768
    buffer_store_dword v148, v225, s[68:71], s9 offen offset:2048 nt
    s_add_u32 s9, s11, 36864
    buffer_store_dword v149, v225, s[68:71], s9 offen offset:2048 nt
    s_add_u32 s9, s11, 40960
    buffer_store_dword v150, v225, s[68:71], s9 offen offset:2048 nt
    s_add_u32 s9, s11, 45056
    buffer_store_dword v151, v225, s[68:71], s9 offen offset:2048 nt
    s_add_u32 s9, s11, 65536
    buffer_store_dword v152, v225, s[68:71], s9 offen offset:2048 nt
    s_add_u32 s9, s11, 69632
    buffer_store_dword v153, v225, s[68:71], s9 offen offset:2048 nt
    s_add_u32 s9, s11, 73728
    buffer_store_dword v154, v225, s[68:71], s9 offen offset:2048 nt
    s_add_u32 s9, s11, 77824
    buffer_store_dword v155, v225, s[68:71], s9 offen offset:2048 nt
    s_add_u32 s9, s11, 98304
    buffer_store_dword v156, v225, s[68:71], s9 offen offset:2048 nt
    s_add_u32 s9, s11, 102400
    buffer_store_dword v157, v225, s[68:71], s9 offen offset:2048 nt
    s_add_u32 s9, s11, 106496
    buffer_store_dword v158, v225, s[68:71], s9 offen offset:2048 nt
    s_add_u32 s9, s11, 110592
    buffer_store_dword v159, v225, s[68:71], s9 offen offset:2048 nt
    s_endpgm
L_attn:
    v_and_b32 v240, 11, v250
    v_cmp_eq_u32 vcc, 0, v240
    v_mov_b32 v240, 0x3f803f80
    s_nop 0
    v_cndmask_b32 v249, 0, v240, vcc
    v_mov_b32 v68, v249
    v_mov_b32 v69, v249
    v_mov_b32 v70, v249
    v_mov_b32 v71, v249
    v_mov_b32 v76, v249
    v_mov_b32 v77, v249
    v_mov_b32 v78, v249
    v_mov_b32 v79, v249
    v_mov_b32 v84, v249
    v_mov_b32 v85, v249
    v_mov_b32 v86, v249
    v_mov_b32 v87, v249
    v_mov_b32 v92, v249
    v_mov_b32 v93, v249
    v_mov_b32 v94, v249
    v_mov_b32 v95, v249
    v_mov_b32 v100, v249
    v_mov_b32 v101, v249
    v_mov_b32 v102, v249
    v_mov_b32 v103, v249
    v_mov_b32 v108, v249
    v_mov_b32 v109, v249
    v_mov_b32 v110, v249
    v_mov_b32 v111, v249
    v_mov_b32 v116, v249
    v_mov_b32 v117, v249
    v_mov_b32 v118, v249
    v_mov_b32 v119, v249
    v_mov_b32 v124, v249
    v_mov_b32 v125, v249
    v_mov_b32 v126, v249
    v_mov_b32 v127, v249
    v_mov_b32 v132, v249
    v_mov_b32 v133, v249
    v_mov_b32 v134, v249
    v_mov_b32 v135, v249
    v_mov_b32 v140, v249
    v_mov_b32 v141, v249
    v_mov_b32 v142, v249
    v_mov_b32 v143, v249
    v_mov_b32 v148, v249
    v_mov_b32 v149, v249
    v_mov_b32 v150, v249
    v_mov_b32 v151, v249
    v_mov_b32 v156, v249
    v_mov_b32 v157, v249
    v_mov_b32 v158, v249
    v_mov_b32 v159, v249
    v_mov_b32 v164, v249
    v_mov_b32 v165, v249
    v_mov_b32 v166, v249
    v_mov_b32 v167, v249
    v_mov_b32 v172, v249
    v_mov_b32 v173, v249
    v_mov_b32 v174, v249
    v_mov_b32 v175, v249
    v_mov_b32 v180, v249
    v_mov_b32 v181, v249
    v_mov_b32 v182, v249
    v_mov_b32 v183, v249
    v_mov_b32 v188, v249
    v_mov_b32 v189, v249
    v_mov_b32 v190, v249
    v_mov_b32 v191, v249
    v_lshlrev_b32 v248, 3, v250
    v_mov_b32 v244, 0xdddd
    v_mov_b32 v224, 0
    v_mov_b32 v225, 0
    v_mov_b32 v226, 0
    v_mov_b32 v227, 0
    v_mov_b32 v228, 0
    v_mov_b32 v229, 0
    v_mov_b32 v230, 0
    v_mov_b32 v231, 0
    v_mov_b32 v232, 0
    v_mov_b32 v233, 0
    v_mov_b32 v234, 0
    v_mov_b32 v235, 0
    v_mov_b32 v236, 0
    v_mov_b32 v237, 0
    v_mov_b32 v238, 0
    v_mov_b32 v239, 0
    s_mov_b32 s74, s72
    s_mov_b32 s73, 0
    s_lshl_b32 s9, s74, 10
    v_add_u32 v247, s9, v251
    s_lshl_b32 s9, s74, 11
    v_add_u32 v245, s9, v251
    s_lshl_b32 s9, s74, 9
    v_add_u32 v246, s9, v248
    v_lshlrev_b32 v196, 6, v250
    v_mov_b32 v195, 0
    s_lshl_b32 s12, s3, 12
    s_add_u32 s12, s12, 0x8000
    s_lshl_b32 s13, s3, 15
    s_add_u32 s13, s13, 0x10000
    s_lshl_b32 s9, s5, 12
    s_add_u32 s13, s13, s9
    s_lshl_b32 s75, s4, 16
    s_lshl_b32 s9, s5, 12
    s_add_u32 s75, s75, s9
    s_add_u32 s75, s75, 0x100000
    s_add_u32 s9, s72, 1
    s_and_b32 s9, s9, 3
    s_lshl_b32 s9, s9, 10
    s_add_u32 s75, s75, s9
    s_mov_b32 s76, 0xffff
    s_mov_b32 s77, 0xffff
    s_lshl_b32 s101, s4, 16
    s_lshr_b32 s9, s72, 1
    s_lshl_b32 s9, s9, 2
    s_and_b32 s11, s5, 3
    s_add_u32 s9, s9, s11
    s_lshl_b32 s9, s9, 12
    s_add_u32 s101, s101, s9
    s_add_u32 s101, s101, 0x100000
    s_mov_b32 s81, 0
    v_bfe_u32 v0, v250, 4, 1
    v_lshlrev_b32 v0, 5, v0
    v_and_b32 v1, 3, v250
    v_lshl_add_u32 v0, v1, 3, v0
    v_bfe_u32 v1, v250, 2, 2
    s_and_b32 s9, s72, 1
    v_lshrrev_b32 v2, 1, v1
    v_xor_b32 v2, s9, v2
    v_lshl_add_u32 v2, v2, 6, v0
    v_lshl_add_u32 v2, v1, 7, v2
    v_lshrrev_b32 v1, 5, v250
    v_lshl_add_u32 v2, v1, 9, v2
    s_lshr_b32 s9, s72, 1
    s_lshl_b32 s9, s9, 15
    s_add_u32 s9, s9, 29696
    v_add_u32 v250, s9, v2
    s_waitcnt vmcnt(0)
    ds_write_b32 v254, v255 offset:48
    s_mov_b32 s15, 400000
W_33:
    ds_read_b32 v249, v253 offset:432
    s_waitcnt lgkmcnt(0)
    v_cmp_eq_u32 vcc, 0, v249
    s_nop 0
    s_cbranch_vccz WD_34
    s_sleep 1
    s_sub_u32 s15, s15, 1
    s_cbranch_scc0 W_33
WD_34:
    ds_read_b32 v252, v253 offset:416
    s_waitcnt lgkmcnt(0)
    v_readfirstlane_b32 s8, v252
    s_mov_b32 s15, 100000
    s_lshr_b32 s9, s2, 3
    s_lshl_b32 s9, s9, 2
    s_add_u32 s9, s9, s72
    s_lshl_b32 s9, s9, 10
    s_add_u32 s9, s9, 0x10000
L_kvp:
    buffer_load_dwordx3 v[192:194], v196, s[64:67], s12 offen sc1
    s_waitcnt vmcnt(0)
    v_cmp_ne_u32 vcc, s8, v192
    s_nop 0
    s_cbranch_vccz L_kvpd
    s_mov_b64 exec, vcc
    s_sleep 1
    s_sub_u32 s15, s15, 1
    s_cbranch_scc0 L_kvp
L_kvpd:
    s_mov_b64 exec, -1
    buffer_load_dwordx4 v[0:3], v251, s[64:67], s13 offen offset:0 sc1
    buffer_load_dwordx4 v[64:67], v251, s[64:67], s13 offen offset:1024 sc1
    buffer_load_dwordx4 v[4:7], v251, s[64:67], s13 offen offset:2048 sc1
    buffer_load_dwordx4 v[72:75], v251, s[64:67], s13 offen offset:3072 sc1
    s_xor_b32 s13, s13, 0x1000
    buffer_load_dwordx4 v[8:11], v251, s[64:67], s13 offen offset:0 sc1
    buffer_load_dwordx4 v[80:83], v251, s[64:67], s13 offen offset:1024 sc1
    buffer_load_dwordx4 v[12:15], v251, s[64:67], s13 offen offset:2048 sc1
    buffer_load_dwordx4 v[88:91], v251, s[64:67], s13 offen offset:3072 sc1
    s_xor_b32 s13, s13, 0x3000
    buffer_load_dwordx4 v[16:19], v251, s[64:67], s13 offen offset:0 sc1
    buffer_load_dwordx4 v[96:99], v251, s[64:67], s13 offen offset:1024 sc1
    buffer_load_dwordx4 v[20:23], v251, s[64:67], s13 offen offset:2048 sc1
    buffer_load_dwordx4 v[104:107], v251, s[64:67], s13 offen offset:3072 sc1
    s_xor_b32 s13, s13, 0x1000
    buffer_load_dwordx4 v[24:27], v251, s[64:67], s13 offen offset:0 sc1
    buffer_load_dwordx4 v[112:115], v251, s[64:67], s13 offen offset:1024 sc1
    ds_max_u32 v195, v193 offset:400
    s_mov_b32 s15, 400000
W_35:
    ds_read_b32 v249, v253 offset:64
    s_waitcnt lgkmcnt(0)
    v_cmp_eq_u32 vcc, 0, v249
    s_nop 0
    s_cbranch_vccz WD_36
    s_sub_u32 s15, s15, 1
    s_cbranch_scc0 W_35
WD_36:
    ds_read_b128 v[240:243], v247 offset:5120
    s_sub_u32 s9, s72, 1
    s_and_b32 s9, s9, 3
    s_lshl_b32 s50, s9, 9
    s_lshl_b32 s51, s9, 10
    s_lshl_b32 s80, s9, 11
    s_sub_u32 s9, s72, 2
    s_and_b32 s9, s9, 3
    s_lshl_b32 s10, s9, 9
    s_lshl_b32 s11, s9, 10
    s_lshl_b32 s12, s9, 11
    s_sub_u32 s9, s72, 3
    s_and_b32 s9, s9, 3
    s_lshl_b32 s14, s9, 9
    s_lshl_b32 s73, s9, 10
    s_lshl_b32 s74, s9, 11
    s_setprio 1
    s_waitcnt vmcnt(13) lgkmcnt(0)
    v_mfma_f32_32x32x16_bf16 v[192:207], v[0:3], v[240:243], -4.0
    s_nop 11
    v_exp_f32 v192, v192
    v_exp_f32 v193, v193
    v_exp_f32 v194, v194
    v_exp_f32 v195, v195
    v_exp_f32 v196, v196
    s_waitcnt vmcnt(11)
    v_mfma_f32_32x32x16_bf16 v[208:223], v[4:7], v[240:243], -4.0
    v_permlane16_swap_b32 v64, v68
    v_permlane16_swap_b32 v65, v69
    v_permlane16_swap_b32 v66, v70
    v_permlane16_swap_b32 v67, v71
    v_exp_f32 v197, v197
    v_exp_f32 v198, v198
    buffer_load_dwordx4 v[28:31], v251, s[64:67], s13 offen offset:2048 sc1
    buffer_load_dwordx4 v[120:123], v251, s[64:67], s13 offen offset:3072 sc1
    s_xor_b32 s13, s13, 0x7000
    buffer_load_dwordx4 v[32:35], v251, s[64:67], s13 offen offset:0 sc1
    buffer_load_dwordx4 v[128:131], v251, s[64:67], s13 offen offset:1024 sc1
    buffer_load_dwordx4 v[36:39], v251, s[64:67], s13 offen offset:2048 sc1
    buffer_load_dwordx4 v[136:139], v251, s[64:67], s13 offen offset:3072 sc1
    v_exp_f32 v199, v199
    v_exp_f32 v200, v200
    v_exp_f32 v201, v201
    v_exp_f32 v202, v202
    v_exp_f32 v203, v203
    v_exp_f32 v204, v204
    v_exp_f32 v205, v205
    v_exp_f32 v206, v206
    v_smfmac_f32_32x32x32_bf16 v[224:239], v[64:67], v[192:199], v244
    v_exp_f32 v207, v207
    v_exp_f32 v208, v208
    v_exp_f32 v209, v209
    v_smfmac_f32_32x32x32_bf16 v[224:239], v[68:71], v[200:207], v244
    v_exp_f32 v210, v210
    v_exp_f32 v211, v211
    v_exp_f32 v212, v212
    s_waitcnt vmcnt(15)
    v_mfma_f32_32x32x16_bf16 v[192:207], v[8:11], v[240:243], -4.0
    v_permlane16_swap_b32 v72, v76
    v_permlane16_swap_b32 v73, v77
    v_permlane16_swap_b32 v74, v78
    v_permlane16_swap_b32 v75, v79
    v_exp_f32 v213, v213
    v_exp_f32 v214, v214
    s_xor_b32 s13, s13, 0x1000
    buffer_load_dwordx4 v[40:43], v251, s[64:67], s13 offen offset:0 sc1
    buffer_load_dwordx4 v[144:147], v251, s[64:67], s13 offen offset:1024 sc1
    buffer_load_dwordx4 v[44:47], v251, s[64:67], s13 offen offset:2048 sc1
    buffer_load_dwordx4 v[152:155], v251, s[64:67], s13 offen offset:3072 sc1
    s_xor_b32 s13, s13, 0x3000
    buffer_load_dwordx4 v[48:51], v251, s[64:67], s13 offen offset:0 sc1
    buffer_load_dwordx4 v[160:163], v251, s[64:67], s13 offen offset:1024 sc1
    v_exp_f32 v215, v215
    v_exp_f32 v216, v216
    v_exp_f32 v217, v217
    v_exp_f32 v218, v218
    v_exp_f32 v219, v219
    v_exp_f32 v220, v220
    v_exp_f32 v221, v221
    v_exp_f32 v222, v222
    v_smfmac_f32_32x32x32_bf16 v[224:239], v[72:75], v[208:215], v244
    v_exp_f32 v223, v223
    v_exp_f32 v192, v192
    v_exp_f32 v193, v193
    v_smfmac_f32_32x32x32_bf16 v[224:239], v[76:79], v[216:223], v244
    v_exp_f32 v194, v194
    v_exp_f32 v195, v195
    v_exp_f32 v196, v196
    s_waitcnt vmcnt(13)
    v_mfma_f32_32x32x16_bf16 v[208:223], v[12:15], v[240:243], -4.0
    v_permlane16_swap_b32 v80, v84
    v_permlane16_swap_b32 v81, v85
    v_permlane16_swap_b32 v82, v86
    v_permlane16_swap_b32 v83, v87
    v_exp_f32 v197, v197
    v_exp_f32 v198, v198
    buffer_load_dwordx4 v[52:55], v251, s[64:67], s13 offen offset:2048 sc1
    buffer_load_dwordx4 v[168:171], v251, s[64:67], s13 offen offset:3072 sc1
    s_xor_b32 s13, s13, 0x1000
    buffer_load_dwordx4 v[56:59], v251, s[64:67], s13 offen offset:0 sc1
    buffer_load_dwordx4 v[176:179], v251, s[64:67], s13 offen offset:1024 sc1
    buffer_load_dwordx4 v[60:63], v251, s[64:67], s13 offen offset:2048 sc1
    buffer_load_dwordx4 v[184:187], v251, s[64:67], s13 offen offset:3072 sc1
    ds_write_b32 v254, v255 offset:96
    v_exp_f32 v199, v199
    v_exp_f32 v200, v200
    v_exp_f32 v201, v201
    v_exp_f32 v202, v202
    v_exp_f32 v203, v203
    v_exp_f32 v204, v204
    v_exp_f32 v205, v205
    v_exp_f32 v206, v206
    v_smfmac_f32_32x32x32_bf16 v[224:239], v[80:83], v[192:199], v244
    v_exp_f32 v207, v207
    v_exp_f32 v208, v208
    v_exp_f32 v209, v209
    v_smfmac_f32_32x32x32_bf16 v[224:239], v[84:87], v[200:207], v244
    v_exp_f32 v210, v210
    v_exp_f32 v211, v211
    v_exp_f32 v212, v212
    v_mfma_f32_32x32x16_bf16 v[192:207], v[16:19], v[240:243], -4.0
    v_permlane16_swap_b32 v88, v92
    v_permlane16_swap_b32 v89, v93
    v_permlane16_swap_b32 v90, v94
    v_permlane16_swap_b32 v91, v95
    v_exp_f32 v213, v213
    v_exp_f32 v214, v214
    v_exp_f32 v215, v215
    v_exp_f32 v216, v216
    v_exp_f32 v217, v217
    v_exp_f32 v218, v218
    v_exp_f32 v219, v219
    v_exp_f32 v220, v220
    v_exp_f32 v221, v221
    v_exp_f32 v222, v222
    v_smfmac_f32_32x32x32_bf16 v[224:239], v[88:91], v[208:215], v244
    v_exp_f32 v223, v223
    v_exp_f32 v192, v192
    v_exp_f32 v193, v193
    v_smfmac_f32_32x32x32_bf16 v[224:239], v[92:95], v[216:223], v244
    v_exp_f32 v194, v194
    v_exp_f32 v195, v195
    v_exp_f32 v196, v196
    v_mfma_f32_32x32x16_bf16 v[208:223], v[20:23], v[240:243], -4.0
    v_permlane16_swap_b32 v96, v100
    v_permlane16_swap_b32 v97, v101
    v_permlane16_swap_b32 v98, v102
    v_permlane16_swap_b32 v99, v103
    v_exp_f32 v197, v197
    v_exp_f32 v198, v198
    v_exp_f32 v199, v199
    v_exp_f32 v200, v200
    v_exp_f32 v201, v201
    v_exp_f32 v202, v202
    v_exp_f32 v203, v203
    v_exp_f32 v204, v204
    v_exp_f32 v205, v205
    v_exp_f32 v206, v206
    v_smfmac_f32_32x32x32_bf16 v[224:239], v[96:99], v[192:199], v244
    v_exp_f32 v207, v207
    v_exp_f32 v208, v208
    v_exp_f32 v209, v209
    v_smfmac_f32_32x32x32_bf16 v[224:239], v[100:103], v[200:207], v244
    v_exp_f32 v210, v210
    v_exp_f32 v211, v211
    v_exp_f32 v212, v212
    v_mfma_f32_32x32x16_bf16 v[192:207], v[24:27], v[240:243], -4.0
    v_permlane16_swap_b32 v104, v108
    v_permlane16_swap_b32 v105, v109
    v_permlane16_swap_b32 v106, v110
    v_permlane16_swap_b32 v107, v111
    v_exp_f32 v213, v213
    v_exp_f32 v214, v214
    v_exp_f32 v215, v215
    v_exp_f32 v216, v216
    v_exp_f32 v217, v217
    v_exp_f32 v218, v218
    v_exp_f32 v219, v219
    v_exp_f32 v220, v220
    v_exp_f32 v221, v221
    v_exp_f32 v222, v222
    v_smfmac_f32_32x32x32_bf16 v[224:239], v[104:107], v[208:215], v244
    v_exp_f32 v223, v223
    v_exp_f32 v192, v192
    v_exp_f32 v193, v193
    v_smfmac_f32_32x32x32_bf16 v[224:239], v[108:111], v[216:223], v244
    v_exp_f32 v194, v194
    v_exp_f32 v195, v195
    v_exp_f32 v196, v196
    s_waitcnt vmcnt(11)
    v_mfma_f32_32x32x16_bf16 v[208:223], v[28:31], v[240:243], -4.0
    v_permlane16_swap_b32 v112, v116
    v_permlane16_swap_b32 v113, v117
    v_permlane16_swap_b32 v114, v118
    v_permlane16_swap_b32 v115, v119
    v_exp_f32 v197, v197
    v_exp_f32 v198, v198
    v_exp_f32 v199, v199
    v_exp_f32 v200, v200
    v_exp_f32 v201, v201
    v_exp_f32 v202, v202
    v_exp_f32 v203, v203
    v_exp_f32 v204, v204
    v_exp_f32 v205, v205
    v_exp_f32 v206, v206
    v_smfmac_f32_32x32x32_bf16 v[224:239], v[112:115], v[192:199], v244
    v_exp_f32 v207, v207
    v_exp_f32 v208, v208
    v_exp_f32 v209, v209
    v_smfmac_f32_32x32x32_bf16 v[224:239], v[116:119], v[200:207], v244
    v_exp_f32 v210, v210
    v_exp_f32 v211, v211
    v_exp_f32 v212, v212
    v_mfma_f32_32x32x16_bf16 v[192:207], v[32:35], v[240:243], -4.0
    v_permlane16_swap_b32 v120, v124
    v_permlane16_swap_b32 v121, v125
    v_permlane16_swap_b32 v122, v126
    v_permlane16_swap_b32 v123, v127
    v_exp_f32 v213, v213
    v_exp_f32 v214, v214
    v_exp_f32 v215, v215
    v_exp_f32 v216, v216
    v_exp_f32 v217, v217
    v_exp_f32 v218, v218
    v_exp_f32 v219, v219
    v_exp_f32 v220, v220
    v_exp_f32 v221, v221
    v_exp_f32 v222, v222
    v_smfmac_f32_32x32x32_bf16 v[224:239], v[120:123], v[208:215], v244
    v_exp_f32 v223, v223
    v_exp_f32 v192, v192
    v_exp_f32 v193, v193
    v_smfmac_f32_32x32x32_bf16 v[224:239], v[124:127], v[216:223], v244
    v_exp_f32 v194, v194
    v_exp_f32 v195, v195
    v_exp_f32 v196, v196
    v_mfma_f32_32x32x16_bf16 v[208:223], v[36:39], v[240:243], -4.0
    v_permlane16_swap_b32 v128, v132
    v_permlane16_swap_b32 v129, v133
    v_permlane16_swap_b32 v130, v134
    v_permlane16_swap_b32 v131, v135
    v_exp_f32 v197, v197
    v_exp_f32 v198, v198
    v_exp_f32 v199, v199
    v_exp_f32 v200, v200
    v_exp_f32 v201, v201
    v_exp_f32 v202, v202
    v_exp_f32 v203, v203
    v_exp_f32 v204, v204
    v_exp_f32 v205, v205
    v_exp_f32 v206, v206
    v_smfmac_f32_32x32x32_bf16 v[224:239], v[128:131], v[192:199], v244
    v_exp_f32 v207, v207
    v_exp_f32 v208, v208
    v_exp_f32 v209, v209
    v_smfmac_f32_32x32x32_bf16 v[224:239], v[132:135], v[200:207], v244
    v_exp_f32 v210, v210
    v_exp_f32 v211, v211
    v_exp_f32 v212, v212
    v_mfma_f32_32x32x16_bf16 v[192:207], v[40:43], v[240:243], -4.0
    v_permlane16_swap_b32 v136, v140
    v_permlane16_swap_b32 v137, v141
    v_permlane16_swap_b32 v138, v142
    v_permlane16_swap_b32 v139, v143
    v_exp_f32 v213, v213
    v_exp_f32 v214, v214
    v_exp_f32 v215, v215
    v_exp_f32 v216, v216
    v_exp_f32 v217, v217
    v_exp_f32 v218, v218
    v_exp_f32 v219, v219
    v_exp_f32 v220, v220
    v_exp_f32 v221, v221
    v_exp_f32 v222, v222
    v_smfmac_f32_32x32x32_bf16 v[224:239], v[136:139], v[208:215], v244
    v_exp_f32 v223, v223
    v_exp_f32 v192, v192
    v_exp_f32 v193, v193
    v_smfmac_f32_32x32x32_bf16 v[224:239], v[140:143], v[216:223], v244
    v_exp_f32 v194, v194
    v_exp_f32 v195, v195
    v_exp_f32 v196, v196
    s_waitcnt vmcnt(3)
    v_mfma_f32_32x32x16_bf16 v[208:223], v[44:47], v[240:243], -4.0
    v_permlane16_swap_b32 v144, v148
    v_permlane16_swap_b32 v145, v149
    v_permlane16_swap_b32 v146, v150
    v_permlane16_swap_b32 v147, v151
    v_exp_f32 v197, v197
    v_exp_f32 v198, v198
    v_exp_f32 v199, v199
    v_exp_f32 v200, v200
    v_exp_f32 v201, v201
    v_exp_f32 v202, v202
    v_exp_f32 v203, v203
    v_exp_f32 v204, v204
    v_exp_f32 v205, v205
    v_exp_f32 v206, v206
    v_smfmac_f32_32x32x32_bf16 v[224:239], v[144:147], v[192:199], v244
    v_exp_f32 v207, v207
    v_exp_f32 v208, v208
    v_exp_f32 v209, v209
    v_smfmac_f32_32x32x32_bf16 v[224:239], v[148:151], v[200:207], v244
    v_exp_f32 v210, v210
    v_exp_f32 v211, v211
    v_exp_f32 v212, v212
    v_mfma_f32_32x32x16_bf16 v[192:207], v[48:51], v[240:243], -4.0
    v_permlane16_swap_b32 v152, v156
    v_permlane16_swap_b32 v153, v157
    v_permlane16_swap_b32 v154, v158
    v_permlane16_swap_b32 v155, v159
    v_exp_f32 v213, v213
    v_exp_f32 v214, v214
    v_exp_f32 v215, v215
    v_exp_f32 v216, v216
    v_exp_f32 v217, v217
    v_exp_f32 v218, v218
    v_exp_f32 v219, v219
    v_exp_f32 v220, v220
    v_exp_f32 v221, v221
    v_exp_f32 v222, v222
    v_smfmac_f32_32x32x32_bf16 v[224:239], v[152:155], v[208:215], v244
    v_exp_f32 v223, v223
    v_exp_f32 v192, v192
    v_exp_f32 v193, v193
    v_smfmac_f32_32x32x32_bf16 v[224:239], v[156:159], v[216:223], v244
    v_exp_f32 v194, v194
    v_exp_f32 v195, v195
    v_exp_f32 v196, v196
    v_mfma_f32_32x32x16_bf16 v[208:223], v[52:55], v[240:243], -4.0
    v_permlane16_swap_b32 v160, v164
    v_permlane16_swap_b32 v161, v165
    v_permlane16_swap_b32 v162, v166
    v_permlane16_swap_b32 v163, v167
    v_exp_f32 v197, v197
    v_exp_f32 v198, v198
    v_exp_f32 v199, v199
    v_exp_f32 v200, v200
    v_exp_f32 v201, v201
    v_exp_f32 v202, v202
    v_exp_f32 v203, v203
    v_exp_f32 v204, v204
    v_exp_f32 v205, v205
    v_exp_f32 v206, v206
    v_smfmac_f32_32x32x32_bf16 v[224:239], v[160:163], v[192:199], v244
    v_exp_f32 v207, v207
    v_exp_f32 v208, v208
    v_exp_f32 v209, v209
    v_smfmac_f32_32x32x32_bf16 v[224:239], v[164:167], v[200:207], v244
    v_exp_f32 v210, v210
    v_exp_f32 v211, v211
    v_exp_f32 v212, v212
    v_mfma_f32_32x32x16_bf16 v[192:207], v[56:59], v[240:243], -4.0
    v_permlane16_swap_b32 v168, v172
    v_permlane16_swap_b32 v169, v173
    v_permlane16_swap_b32 v170, v174
    v_permlane16_swap_b32 v171, v175
    v_exp_f32 v213, v213
    v_exp_f32 v214, v214
    v_exp_f32 v215, v215
    v_exp_f32 v216, v216
    v_exp_f32 v217, v217
    v_exp_f32 v218, v218
    v_exp_f32 v219, v219
    v_exp_f32 v220, v220
    v_exp_f32 v221, v221
    v_exp_f32 v222, v222
    v_smfmac_f32_32x32x32_bf16 v[224:239], v[168:171], v[208:215], v244
    v_exp_f32 v223, v223
    v_exp_f32 v192, v192
    v_exp_f32 v193, v193
    v_smfmac_f32_32x32x32_bf16 v[224:239], v[172:175], v[216:223], v244
    v_exp_f32 v194, v194
    v_exp_f32 v195, v195
    v_exp_f32 v196, v196
    s_waitcnt vmcnt(0)
    v_mfma_f32_32x32x16_bf16 v[208:223], v[60:63], v[240:243], -4.0
    v_permlane16_swap_b32 v176, v180
    v_permlane16_swap_b32 v177, v181
    v_permlane16_swap_b32 v178, v182
    v_permlane16_swap_b32 v179, v183
    v_exp_f32 v197, v197
    v_exp_f32 v198, v198
    ds_read_b128 v[240:243], v247 offset:9216
    v_exp_f32 v199, v199
    v_exp_f32 v200, v200
    v_exp_f32 v201, v201
    v_exp_f32 v202, v202
    v_exp_f32 v203, v203
    v_exp_f32 v204, v204
    v_exp_f32 v205, v205
    v_exp_f32 v206, v206
    v_smfmac_f32_32x32x32_bf16 v[224:239], v[176:179], v[192:199], v244
    v_exp_f32 v207, v207
    v_exp_f32 v208, v208
    v_exp_f32 v209, v209
    v_smfmac_f32_32x32x32_bf16 v[224:239], v[180:183], v[200:207], v244
    v_exp_f32 v210, v210
    v_exp_f32 v211, v211
    v_exp_f32 v212, v212
    s_waitcnt lgkmcnt(0)
    v_mfma_f32_32x32x16_bf16 v[192:207], v[0:3], v[240:243], -4.0
    v_permlane16_swap_b32 v184, v188
    v_permlane16_swap_b32 v185, v189
    v_permlane16_swap_b32 v186, v190
    v_permlane16_swap_b32 v187, v191
    v_exp_f32 v213, v213
    v_exp_f32 v214, v214
    v_exp_f32 v215, v215
    v_exp_f32 v216, v216
    v_exp_f32 v217, v217
    v_exp_f32 v218, v218
    v_exp_f32 v219, v219
    v_exp_f32 v220, v220
    v_exp_f32 v221, v221
    v_exp_f32 v222, v222
    v_smfmac_f32_32x32x32_bf16 v[224:239], v[184:187], v[208:215], v244
    v_exp_f32 v223, v223
    v_exp_f32 v192, v192
    v_exp_f32 v193, v193
    v_smfmac_f32_32x32x32_bf16 v[224:239], v[188:191], v[216:223], v244
    v_exp_f32 v194, v194
    v_exp_f32 v195, v195
    v_exp_f32 v196, v196
    v_mfma_f32_32x32x16_bf16 v[208:223], v[4:7], v[240:243], -4.0
    v_exp_f32 v197, v197
    v_exp_f32 v198, v198
    v_exp_f32 v199, v199
    ds_write_b128 v245, v[224:227] offset:13312
    v_mov_b32 v233, 2
    ds_write_b128 v245, v[228:231] offset:14336
    ds_write_b64 v246, v[232:233] offset:1024
    v_pk_mul_f32 v[224:225], v[234:235], v[234:235]
    v_pk_mul_f32 v[226:227], v[234:235], v[234:235]
    v_pk_mul_f32 v[228:229], v[234:235], v[234:235]
    v_pk_mul_f32 v[230:231], v[234:235], v[234:235]
    v_mov_b32 v232, 0
    v_exp_f32 v200, v200
    v_exp_f32 v201, v201
    v_exp_f32 v202, v202
    v_exp_f32 v203, v203
    v_exp_f32 v204, v204
    v_exp_f32 v205, v205
    v_exp_f32 v206, v206
    v_smfmac_f32_32x32x32_bf16 v[224:239], v[64:67], v[192:199], v244
    v_exp_f32 v207, v207
    v_exp_f32 v208, v208
    v_exp_f32 v209, v209
    v_smfmac_f32_32x32x32_bf16 v[224:239], v[68:71], v[200:207], v244
    v_exp_f32 v210, v210
    v_exp_f32 v211, v211
    v_exp_f32 v212, v212
    v_mfma_f32_32x32x16_bf16 v[192:207], v[8:11], v[240:243], -4.0
    v_exp_f32 v213, v213
    v_exp_f32 v214, v214
    v_exp_f32 v215, v215
    v_exp_f32 v216, v216
    v_exp_f32 v217, v217
    v_exp_f32 v218, v218
    v_exp_f32 v219, v219
    v_exp_f32 v220, v220
    v_exp_f32 v221, v221
    v_exp_f32 v222, v222
    v_smfmac_f32_32x32x32_bf16 v[224:239], v[72:75], v[208:215], v244
    v_exp_f32 v223, v223
    v_exp_f32 v192, v192
    v_exp_f32 v193, v193
    v_smfmac_f32_32x32x32_bf16 v[224:239], v[76:79], v[216:223], v244
    v_exp_f32 v194, v194
    v_exp_f32 v195, v195
    v_exp_f32 v196, v196
    v_mfma_f32_32x32x16_bf16 v[208:223], v[12:15], v[240:243], -4.0
    v_exp_f32 v197, v197
    v_exp_f32 v198, v198
    v_exp_f32 v199, v199
    v_exp_f32 v200, v200
    v_exp_f32 v201, v201
    v_exp_f32 v202, v202
    v_exp_f32 v203, v203
    v_exp_f32 v204, v204
    v_exp_f32 v205, v205
    v_exp_f32 v206, v206
    v_smfmac_f32_32x32x32_bf16 v[224:239], v[80:83], v[192:199], v244
    v_exp_f32 v207, v207
    v_exp_f32 v208, v208
    v_exp_f32 v209, v209
    v_smfmac_f32_32x32x32_bf16 v[224:239], v[84:87], v[200:207], v244
    v_exp_f32 v210, v210
    v_exp_f32 v211, v211
    v_exp_f32 v212, v212
    v_mfma_f32_32x32x16_bf16 v[192:207], v[16:19], v[240:243], -4.0
    v_exp_f32 v213, v213
    v_exp_f32 v214, v214
    v_exp_f32 v215, v215
    v_exp_f32 v216, v216
    v_exp_f32 v217, v217
    v_exp_f32 v218, v218
    v_exp_f32 v219, v219
    v_exp_f32 v220, v220
    v_exp_f32 v221, v221
    v_exp_f32 v222, v222
    v_smfmac_f32_32x32x32_bf16 v[224:239], v[88:91], v[208:215], v244
    v_exp_f32 v223, v223
    v_exp_f32 v192, v192
    v_exp_f32 v193, v193
    v_smfmac_f32_32x32x32_bf16 v[224:239], v[92:95], v[216:223], v244
    v_exp_f32 v194, v194
    v_exp_f32 v195, v195
    v_exp_f32 v196, v196
    v_mfma_f32_32x32x16_bf16 v[208:223], v[20:23], v[240:243], -4.0
    v_exp_f32 v197, v197
    v_exp_f32 v198, v198
    v_exp_f32 v199, v199
    v_exp_f32 v200, v200
    v_exp_f32 v201, v201
    v_exp_f32 v202, v202
    v_exp_f32 v203, v203
    v_exp_f32 v204, v204
    v_exp_f32 v205, v205
    v_exp_f32 v206, v206
    v_smfmac_f32_32x32x32_bf16 v[224:239], v[96:99], v[192:199], v244
    v_exp_f32 v207, v207
    v_exp_f32 v208, v208
    v_exp_f32 v209, v209
    v_smfmac_f32_32x32x32_bf16 v[224:239], v[100:103], v[200:207], v244
    v_exp_f32 v210, v210
    v_exp_f32 v211, v211
    v_exp_f32 v212, v212
    v_mfma_f32_32x32x16_bf16 v[192:207], v[24:27], v[240:243], -4.0
    v_exp_f32 v213, v213
    v_exp_f32 v214, v214
    v_exp_f32 v215, v215
    v_exp_f32 v216, v216
    v_exp_f32 v217, v217
    v_exp_f32 v218, v218
    v_exp_f32 v219, v219
    v_exp_f32 v220, v220
    v_exp_f32 v221, v221
    v_exp_f32 v222, v222
    v_smfmac_f32_32x32x32_bf16 v[224:239], v[104:107], v[208:215], v244
    v_exp_f32 v223, v223
    v_exp_f32 v192, v192
    v_exp_f32 v193, v193
    v_smfmac_f32_32x32x32_bf16 v[224:239], v[108:111], v[216:223], v244
    v_exp_f32 v194, v194
    v_exp_f32 v195, v195
    v_exp_f32 v196, v196
    v_mfma_f32_32x32x16_bf16 v[208:223], v[28:31], v[240:243], -4.0
    v_exp_f32 v197, v197
    v_exp_f32 v198, v198
    v_exp_f32 v199, v199
    v_exp_f32 v200, v200
    v_exp_f32 v201, v201
    v_exp_f32 v202, v202
    v_exp_f32 v203, v203
    v_exp_f32 v204, v204
    v_exp_f32 v205, v205
    v_exp_f32 v206, v206
    v_smfmac_f32_32x32x32_bf16 v[224:239], v[112:115], v[192:199], v244
    v_exp_f32 v207, v207
    v_exp_f32 v208, v208
    v_exp_f32 v209, v209
    v_smfmac_f32_32x32x32_bf16 v[224:239], v[116:119], v[200:207], v244
    v_exp_f32 v210, v210
    v_exp_f32 v211, v211
    v_exp_f32 v212, v212
    v_mfma_f32_32x32x16_bf16 v[192:207], v[32:35], v[240:243], -4.0
    v_exp_f32 v213, v213
    v_exp_f32 v214, v214
    v_exp_f32 v215, v215
    v_exp_f32 v216, v216
    v_exp_f32 v217, v217
    v_exp_f32 v218, v218
    v_exp_f32 v219, v219
    v_exp_f32 v220, v220
    v_exp_f32 v221, v221
    v_exp_f32 v222, v222
    v_smfmac_f32_32x32x32_bf16 v[224:239], v[120:123], v[208:215], v244
    v_exp_f32 v223, v223
    v_exp_f32 v192, v192
    v_exp_f32 v193, v193
    v_smfmac_f32_32x32x32_bf16 v[224:239], v[124:127], v[216:223], v244
    v_exp_f32 v194, v194
    v_exp_f32 v195, v195
    v_exp_f32 v196, v196
    v_mfma_f32_32x32x16_bf16 v[208:223], v[36:39], v[240:243], -4.0
    v_exp_f32 v197, v197
    v_exp_f32 v198, v198
    v_exp_f32 v199, v199
    v_exp_f32 v200, v200
    v_exp_f32 v201, v201
    v_exp_f32 v202, v202
    v_exp_f32 v203, v203
    v_exp_f32 v204, v204
    v_exp_f32 v205, v205
    v_exp_f32 v206, v206
    v_smfmac_f32_32x32x32_bf16 v[224:239], v[128:131], v[192:199], v244
    v_exp_f32 v207, v207
    v_exp_f32 v208, v208
    v_exp_f32 v209, v209
    v_smfmac_f32_32x32x32_bf16 v[224:239], v[132:135], v[200:207], v244
    v_exp_f32 v210, v210
    v_exp_f32 v211, v211
    v_exp_f32 v212, v212
    v_mfma_f32_32x32x16_bf16 v[192:207], v[40:43], v[240:243], -4.0
    v_exp_f32 v213, v213
    v_exp_f32 v214, v214
    v_exp_f32 v215, v215
    v_exp_f32 v216, v216
    v_exp_f32 v217, v217
    v_exp_f32 v218, v218
    v_exp_f32 v219, v219
    v_exp_f32 v220, v220
    v_exp_f32 v221, v221
    v_exp_f32 v222, v222
    v_smfmac_f32_32x32x32_bf16 v[224:239], v[136:139], v[208:215], v244
    v_exp_f32 v223, v223
    v_exp_f32 v192, v192
    v_exp_f32 v193, v193
    v_smfmac_f32_32x32x32_bf16 v[224:239], v[140:143], v[216:223], v244
    v_exp_f32 v194, v194
    v_exp_f32 v195, v195
    v_exp_f32 v196, v196
    v_mfma_f32_32x32x16_bf16 v[208:223], v[44:47], v[240:243], -4.0
    v_exp_f32 v197, v197
    v_exp_f32 v198, v198
    v_exp_f32 v199, v199
    v_exp_f32 v200, v200
    v_exp_f32 v201, v201
    v_exp_f32 v202, v202
    v_exp_f32 v203, v203
    v_exp_f32 v204, v204
    v_exp_f32 v205, v205
    v_exp_f32 v206, v206
    v_smfmac_f32_32x32x32_bf16 v[224:239], v[144:147], v[192:199], v244
    v_exp_f32 v207, v207
    v_exp_f32 v208, v208
    v_exp_f32 v209, v209
    v_smfmac_f32_32x32x32_bf16 v[224:239], v[148:151], v[200:207], v244
    v_exp_f32 v210, v210
    v_exp_f32 v211, v211
    v_exp_f32 v212, v212
    v_mfma_f32_32x32x16_bf16 v[192:207], v[48:51], v[240:243], -4.0
    v_exp_f32 v213, v213
    v_exp_f32 v214, v214
    v_exp_f32 v215, v215
    v_exp_f32 v216, v216
    v_exp_f32 v217, v217
    v_exp_f32 v218, v218
    v_exp_f32 v219, v219
    v_exp_f32 v220, v220
    v_exp_f32 v221, v221
    v_exp_f32 v222, v222
    v_smfmac_f32_32x32x32_bf16 v[224:239], v[152:155], v[208:215], v244
    v_exp_f32 v223, v223
    v_exp_f32 v192, v192
    v_exp_f32 v193, v193
    v_smfmac_f32_32x32x32_bf16 v[224:239], v[156:159], v[216:223], v244
    v_exp_f32 v194, v194
    v_exp_f32 v195, v195
    v_exp_f32 v196, v196
    v_mfma_f32_32x32x16_bf16 v[208:223], v[52:55], v[240:243], -4.0
    v_exp_f32 v197, v197
    v_exp_f32 v198, v198
    v_exp_f32 v199, v199
    v_exp_f32 v200, v200
    v_exp_f32 v201, v201
    v_exp_f32 v202, v202
    v_exp_f32 v203, v203
    v_exp_f32 v204, v204
    v_exp_f32 v205, v205
    v_exp_f32 v206, v206
    v_smfmac_f32_32x32x32_bf16 v[224:239], v[160:163], v[192:199], v244
    v_exp_f32 v207, v207
    v_exp_f32 v208, v208
    v_exp_f32 v209, v209
    v_smfmac_f32_32x32x32_bf16 v[224:239], v[164:167], v[200:207], v244
    v_exp_f32 v210, v210
    v_exp_f32 v211, v211
    v_exp_f32 v212, v212
    v_mfma_f32_32x32x16_bf16 v[192:207], v[56:59], v[240:243], -4.0
    v_exp_f32 v213, v213
    v_exp_f32 v214, v214
    v_exp_f32 v215, v215
    v_exp_f32 v216, v216
    v_exp_f32 v217, v217
    v_exp_f32 v218, v218
    v_exp_f32 v219, v219
    v_exp_f32 v220, v220
    v_exp_f32 v221, v221
    v_exp_f32 v222, v222
    v_smfmac_f32_32x32x32_bf16 v[224:239], v[168:171], v[208:215], v244
    v_exp_f32 v223, v223
    v_exp_f32 v192, v192
    v_exp_f32 v193, v193
    v_smfmac_f32_32x32x32_bf16 v[224:239], v[172:175], v[216:223], v244
    v_exp_f32 v194, v194
    v_exp_f32 v195, v195
    v_exp_f32 v196, v196
    v_mfma_f32_32x32x16_bf16 v[208:223], v[60:63], v[240:243], -4.0
    v_exp_f32 v197, v197
    v_exp_f32 v198, v198
    v_add_u32 v247, s51, v251
    ds_read_b128 v[240:243], v247 offset:5120
    ds_read_b32 v249, v253 offset:144
    v_exp_f32 v199, v199
    v_exp_f32 v200, v200
    v_exp_f32 v201, v201
    v_exp_f32 v202, v202
    v_exp_f32 v203, v203
    v_exp_f32 v204, v204
    v_exp_f32 v205, v205
    v_exp_f32 v206, v206
    v_smfmac_f32_32x32x32_bf16 v[224:239], v[176:179], v[192:199], v244
    v_exp_f32 v207, v207
    v_exp_f32 v208, v208
    v_exp_f32 v209, v209
    v_smfmac_f32_32x32x32_bf16 v[224:239], v[180:183], v[200:207], v244
    v_exp_f32 v210, v210
    v_exp_f32 v211, v211
    v_exp_f32 v212, v212
    s_waitcnt lgkmcnt(0)
    v_mfma_f32_32x32x16_bf16 v[192:207], v[0:3], v[240:243], -4.0
    v_cmp_ne_u32 vcc, 1, v249
    v_exp_f32 v213, v213
    v_exp_f32 v214, v214
    s_cbranch_vccnz L_check1
L_checked1:
    v_exp_f32 v215, v215
    v_exp_f32 v216, v216
    v_exp_f32 v217, v217
    v_exp_f32 v218, v218
    v_exp_f32 v219, v219
    v_exp_f32 v220, v220
    v_exp_f32 v221, v221
    v_exp_f32 v222, v222
    v_smfmac_f32_32x32x32_bf16 v[224:239], v[184:187], v[208:215], v244
    v_exp_f32 v223, v223
    v_exp_f32 v192, v192
    v_exp_f32 v193, v193
    v_smfmac_f32_32x32x32_bf16 v[224:239], v[188:191], v[216:223], v244
    v_exp_f32 v194, v194
    v_exp_f32 v195, v195
    v_exp_f32 v196, v196
    v_mfma_f32_32x32x16_bf16 v[208:223], v[4:7], v[240:243], -4.0
    v_exp_f32 v197, v197
    v_exp_f32 v198, v198
    v_exp_f32 v199, v199
    ds_write_b128 v245, v[224:227] offset:21504
    v_mov_b32 v233, 3
    ds_write_b128 v245, v[228:231] offset:22528
    ds_write_b64 v246, v[232:233] offset:3072
    v_add_u32 v246, s50, v248
    v_add_u32 v245, s80, v251
    ds_read_b64 v[232:233], v246 offset:1024
    ds_read_b128 v[224:227], v245 offset:13312
    ds_read_b128 v[228:231], v245 offset:14336
    v_exp_f32 v200, v200
    v_exp_f32 v201, v201
    v_exp_f32 v202, v202
    v_exp_f32 v203, v203
    v_exp_f32 v204, v204
    v_exp_f32 v205, v205
    v_exp_f32 v206, v206
    v_exp_f32 v207, v207
    v_exp_f32 v208, v208
    v_exp_f32 v209, v209
    v_exp_f32 v210, v210
    s_waitcnt lgkmcnt(0)
    v_cmp_gt_u32 vcc, 2, v233
    v_exp_f32 v211, v211
    s_cbranch_vccnz L_hw2
L_hd2:
    v_smfmac_f32_32x32x32_bf16 v[224:239], v[64:67], v[192:199], v244
    v_exp_f32 v212, v212
    v_exp_f32 v213, v213
    v_exp_f32 v214, v214
    v_smfmac_f32_32x32x32_bf16 v[224:239], v[68:71], v[200:207], v244
    v_exp_f32 v215, v215
    v_exp_f32 v216, v216
    v_exp_f32 v217, v217
    v_mfma_f32_32x32x16_bf16 v[192:207], v[8:11], v[240:243], -4.0
    v_exp_f32 v218, v218
    v_exp_f32 v219, v219
    v_exp_f32 v220, v220
    v_smfmac_f32_32x32x32_bf16 v[224:239], v[72:75], v[208:215], v244
    v_exp_f32 v221, v221
    v_exp_f32 v222, v222
    v_exp_f32 v223, v223
    v_exp_f32 v192, v192
    v_exp_f32 v193, v193
    v_smfmac_f32_32x32x32_bf16 v[224:239], v[76:79], v[216:223], v244
    v_exp_f32 v194, v194
    v_exp_f32 v195, v195
    v_exp_f32 v196, v196
    v_mfma_f32_32x32x16_bf16 v[208:223], v[12:15], v[240:243], -4.0
    v_exp_f32 v197, v197
    v_exp_f32 v198, v198
    v_exp_f32 v199, v199
    v_exp_f32 v200, v200
    v_exp_f32 v201, v201
    v_exp_f32 v202, v202
    v_exp_f32 v203, v203
    v_exp_f32 v204, v204
    v_exp_f32 v205, v205
    v_exp_f32 v206, v206
    v_smfmac_f32_32x32x32_bf16 v[224:239], v[80:83], v[192:199], v244
    v_exp_f32 v207, v207
    v_exp_f32 v208, v208
    v_exp_f32 v209, v209
    v_smfmac_f32_32x32x32_bf16 v[224:239], v[84:87], v[200:207], v244
    v_exp_f32 v210, v210
    v_exp_f32 v211, v211
    v_exp_f32 v212, v212
    v_mfma_f32_32x32x16_bf16 v[192:207], v[16:19], v[240:243], -4.0
    v_exp_f32 v213, v213
    v_exp_f32 v214, v214
    v_exp_f32 v215, v215
    v_exp_f32 v216, v216
    v_exp_f32 v217, v217
    v_exp_f32 v218, v218
    v_exp_f32 v219, v219
    v_exp_f32 v220, v220
    v_exp_f32 v221, v221
    v_exp_f32 v222, v222
    v_smfmac_f32_32x32x32_bf16 v[224:239], v[88:91], v[208:215], v244
    v_exp_f32 v223, v223
    v_exp_f32 v192, v192
    v_exp_f32 v193, v193
    v_smfmac_f32_32x32x32_bf16 v[224:239], v[92:95], v[216:223], v244
    v_exp_f32 v194, v194
    v_exp_f32 v195, v195
    v_exp_f32 v196, v196
    v_mfma_f32_32x32x16_bf16 v[208:223], v[20:23], v[240:243], -4.0
    v_exp_f32 v197, v197
    v_exp_f32 v198, v198
    v_exp_f32 v199, v199
    v_exp_f32 v200, v200
    v_exp_f32 v201, v201
    v_exp_f32 v202, v202
    v_exp_f32 v203, v203
    v_exp_f32 v204, v204
    v_exp_f32 v205, v205
    v_exp_f32 v206, v206
    v_smfmac_f32_32x32x32_bf16 v[224:239], v[96:99], v[192:199], v244
    v_exp_f32 v207, v207
    v_exp_f32 v208, v208
    v_exp_f32 v209, v209
    v_smfmac_f32_32x32x32_bf16 v[224:239], v[100:103], v[200:207], v244
    v_exp_f32 v210, v210
    v_exp_f32 v211, v211
    v_exp_f32 v212, v212
    v_mfma_f32_32x32x16_bf16 v[192:207], v[24:27], v[240:243], -4.0
    v_exp_f32 v213, v213
    v_exp_f32 v214, v214
    v_exp_f32 v215, v215
    v_exp_f32 v216, v216
    v_exp_f32 v217, v217
    v_exp_f32 v218, v218
    v_exp_f32 v219, v219
    v_exp_f32 v220, v220
    v_exp_f32 v221, v221
    v_exp_f32 v222, v222
    v_smfmac_f32_32x32x32_bf16 v[224:239], v[104:107], v[208:215], v244
    v_exp_f32 v223, v223
    v_exp_f32 v192, v192
    v_exp_f32 v193, v193
    v_smfmac_f32_32x32x32_bf16 v[224:239], v[108:111], v[216:223], v244
    v_exp_f32 v194, v194
    v_exp_f32 v195, v195
    v_exp_f32 v196, v196
    v_mfma_f32_32x32x16_bf16 v[208:223], v[28:31], v[240:243], -4.0
    v_exp_f32 v197, v197
    v_exp_f32 v198, v198
    v_exp_f32 v199, v199
    v_exp_f32 v200, v200
    v_exp_f32 v201, v201
    v_exp_f32 v202, v202
    v_exp_f32 v203, v203
    v_exp_f32 v204, v204
    v_exp_f32 v205, v205
    v_exp_f32 v206, v206
    v_smfmac_f32_32x32x32_bf16 v[224:239], v[112:115], v[192:199], v244
    v_exp_f32 v207, v207
    v_exp_f32 v208, v208
    v_exp_f32 v209, v209
    v_smfmac_f32_32x32x32_bf16 v[224:239], v[116:119], v[200:207], v244
    v_exp_f32 v210, v210
    v_exp_f32 v211, v211
    v_exp_f32 v212, v212
    v_mfma_f32_32x32x16_bf16 v[192:207], v[32:35], v[240:243], -4.0
    v_exp_f32 v213, v213
    v_exp_f32 v214, v214
    v_exp_f32 v215, v215
    v_exp_f32 v216, v216
    v_exp_f32 v217, v217
    v_exp_f32 v218, v218
    v_exp_f32 v219, v219
    v_exp_f32 v220, v220
    v_exp_f32 v221, v221
    v_exp_f32 v222, v222
    v_smfmac_f32_32x32x32_bf16 v[224:239], v[120:123], v[208:215], v244
    v_exp_f32 v223, v223
    v_exp_f32 v192, v192
    v_exp_f32 v193, v193
    v_smfmac_f32_32x32x32_bf16 v[224:239], v[124:127], v[216:223], v244
    v_exp_f32 v194, v194
    v_exp_f32 v195, v195
    v_exp_f32 v196, v196
    v_mfma_f32_32x32x16_bf16 v[208:223], v[36:39], v[240:243], -4.0
    v_exp_f32 v197, v197
    v_exp_f32 v198, v198
    v_exp_f32 v199, v199
    v_exp_f32 v200, v200
    v_exp_f32 v201, v201
    v_exp_f32 v202, v202
    v_exp_f32 v203, v203
    v_exp_f32 v204, v204
    v_exp_f32 v205, v205
    v_exp_f32 v206, v206
    v_smfmac_f32_32x32x32_bf16 v[224:239], v[128:131], v[192:199], v244
    v_exp_f32 v207, v207
    v_exp_f32 v208, v208
    v_exp_f32 v209, v209
    v_smfmac_f32_32x32x32_bf16 v[224:239], v[132:135], v[200:207], v244
    v_exp_f32 v210, v210
    v_exp_f32 v211, v211
    v_exp_f32 v212, v212
    v_mfma_f32_32x32x16_bf16 v[192:207], v[40:43], v[240:243], -4.0
    v_exp_f32 v213, v213
    v_exp_f32 v214, v214
    v_exp_f32 v215, v215
    v_exp_f32 v216, v216
    v_exp_f32 v217, v217
    v_exp_f32 v218, v218
    v_exp_f32 v219, v219
    v_exp_f32 v220, v220
    v_exp_f32 v221, v221
    v_exp_f32 v222, v222
    v_smfmac_f32_32x32x32_bf16 v[224:239], v[136:139], v[208:215], v244
    v_exp_f32 v223, v223
    v_exp_f32 v192, v192
    v_exp_f32 v193, v193
    v_smfmac_f32_32x32x32_bf16 v[224:239], v[140:143], v[216:223], v244
    v_exp_f32 v194, v194
    v_exp_f32 v195, v195
    v_exp_f32 v196, v196
    v_mfma_f32_32x32x16_bf16 v[208:223], v[44:47], v[240:243], -4.0
    v_exp_f32 v197, v197
    v_exp_f32 v198, v198
    v_exp_f32 v199, v199
    v_exp_f32 v200, v200
    v_exp_f32 v201, v201
    v_exp_f32 v202, v202
    v_exp_f32 v203, v203
    v_exp_f32 v204, v204
    v_exp_f32 v205, v205
    v_exp_f32 v206, v206
    v_smfmac_f32_32x32x32_bf16 v[224:239], v[144:147], v[192:199], v244
    v_exp_f32 v207, v207
    v_exp_f32 v208, v208
    v_exp_f32 v209, v209
    v_smfmac_f32_32x32x32_bf16 v[224:239], v[148:151], v[200:207], v244
    v_exp_f32 v210, v210
    v_exp_f32 v211, v211
    v_exp_f32 v212, v212
    v_mfma_f32_32x32x16_bf16 v[192:207], v[48:51], v[240:243], -4.0
    v_exp_f32 v213, v213
    v_exp_f32 v214, v214
    v_exp_f32 v215, v215
    v_exp_f32 v216, v216
    v_exp_f32 v217, v217
    v_exp_f32 v218, v218
    v_exp_f32 v219, v219
    v_exp_f32 v220, v220
    v_exp_f32 v221, v221
    v_exp_f32 v222, v222
    v_smfmac_f32_32x32x32_bf16 v[224:239], v[152:155], v[208:215], v244
    v_exp_f32 v223, v223
    v_exp_f32 v192, v192
    v_exp_f32 v193, v193
    v_smfmac_f32_32x32x32_bf16 v[224:239], v[156:159], v[216:223], v244
    v_exp_f32 v194, v194
    v_exp_f32 v195, v195
    v_exp_f32 v196, v196
    v_mfma_f32_32x32x16_bf16 v[208:223], v[52:55], v[240:243], -4.0
    v_exp_f32 v197, v197
    v_exp_f32 v198, v198
    v_exp_f32 v199, v199
    v_exp_f32 v200, v200
    v_exp_f32 v201, v201
    v_exp_f32 v202, v202
    v_exp_f32 v203, v203
    v_exp_f32 v204, v204
    v_exp_f32 v205, v205
    v_exp_f32 v206, v206
    v_smfmac_f32_32x32x32_bf16 v[224:239], v[160:163], v[192:199], v244
    v_exp_f32 v207, v207
    v_exp_f32 v208, v208
    v_exp_f32 v209, v209
    v_smfmac_f32_32x32x32_bf16 v[224:239], v[164:167], v[200:207], v244
    v_exp_f32 v210, v210
    v_exp_f32 v211, v211
    v_exp_f32 v212, v212
    v_mfma_f32_32x32x16_bf16 v[192:207], v[56:59], v[240:243], -4.0
    v_exp_f32 v213, v213
    v_exp_f32 v214, v214
    v_exp_f32 v215, v215
    v_exp_f32 v216, v216
    v_exp_f32 v217, v217
    v_exp_f32 v218, v218
    v_exp_f32 v219, v219
    v_exp_f32 v220, v220
    v_exp_f32 v221, v221
    v_exp_f32 v222, v222
    v_smfmac_f32_32x32x32_bf16 v[224:239], v[168:171], v[208:215], v244
    v_exp_f32 v223, v223
    v_exp_f32 v192, v192
    v_exp_f32 v193, v193
    v_smfmac_f32_32x32x32_bf16 v[224:239], v[172:175], v[216:223], v244
    v_exp_f32 v194, v194
    v_exp_f32 v195, v195
    v_exp_f32 v196, v196
    v_mfma_f32_32x32x16_bf16 v[208:223], v[60:63], v[240:243], -4.0
    v_exp_f32 v197, v197
    v_exp_f32 v198, v198
    ds_read_b128 v[240:243], v247 offset:9216
    v_exp_f32 v199, v199
    v_exp_f32 v200, v200
    v_exp_f32 v201, v201
    v_exp_f32 v202, v202
    v_exp_f32 v203, v203
    v_exp_f32 v204, v204
    v_exp_f32 v205, v205
    v_exp_f32 v206, v206
    v_smfmac_f32_32x32x32_bf16 v[224:239], v[176:179], v[192:199], v244
    v_exp_f32 v207, v207
    v_exp_f32 v208, v208
    v_exp_f32 v209, v209
    v_smfmac_f32_32x32x32_bf16 v[224:239], v[180:183], v[200:207], v244
    v_exp_f32 v210, v210
    v_exp_f32 v211, v211
    v_exp_f32 v212, v212
    s_waitcnt lgkmcnt(0)
    v_mfma_f32_32x32x16_bf16 v[192:207], v[0:3], v[240:243], -4.0
    v_exp_f32 v213, v213
    v_exp_f32 v214, v214
    v_exp_f32 v215, v215
    v_exp_f32 v216, v216
    v_exp_f32 v217, v217
    v_exp_f32 v218, v218
    v_exp_f32 v219, v219
    v_exp_f32 v220, v220
    v_exp_f32 v221, v221
    v_exp_f32 v222, v222
    v_smfmac_f32_32x32x32_bf16 v[224:239], v[184:187], v[208:215], v244
    v_exp_f32 v223, v223
    v_exp_f32 v192, v192
    v_exp_f32 v193, v193
    v_smfmac_f32_32x32x32_bf16 v[224:239], v[188:191], v[216:223], v244
    v_exp_f32 v194, v194
    v_exp_f32 v195, v195
    v_exp_f32 v196, v196
    v_mfma_f32_32x32x16_bf16 v[208:223], v[4:7], v[240:243], -4.0
    v_exp_f32 v197, v197
    v_exp_f32 v198, v198
    v_exp_f32 v199, v199
    ds_write_b128 v245, v[224:227] offset:13312
    v_mov_b32 v233, 4
    ds_write_b128 v245, v[228:231] offset:14336
    ds_write_b64 v246, v[232:233] offset:1024
    ds_read_b64 v[232:233], v246 offset:3072
    ds_read_b128 v[224:227], v245 offset:21504
    ds_read_b128 v[228:231], v245 offset:22528
    v_exp_f32 v200, v200
    v_exp_f32 v201, v201
    v_exp_f32 v202, v202
    v_exp_f32 v203, v203
    v_exp_f32 v204, v204
    v_exp_f32 v205, v205
    v_exp_f32 v206, v206
    v_exp_f32 v207, v207
    v_exp_f32 v208, v208
    v_exp_f32 v209, v209
    v_exp_f32 v210, v210
    s_waitcnt lgkmcnt(0)
    v_cmp_gt_u32 vcc, 3, v233
    v_exp_f32 v211, v211
    s_cbranch_vccnz L_hw3
L_hd3:
    v_smfmac_f32_32x32x32_bf16 v[224:239], v[64:67], v[192:199], v244
    v_exp_f32 v212, v212
    v_exp_f32 v213, v213
    v_exp_f32 v214, v214
    v_smfmac_f32_32x32x32_bf16 v[224:239], v[68:71], v[200:207], v244
    v_exp_f32 v215, v215
    v_exp_f32 v216, v216
    v_exp_f32 v217, v217
    v_mfma_f32_32x32x16_bf16 v[192:207], v[8:11], v[240:243], -4.0
    v_exp_f32 v218, v218
    v_exp_f32 v219, v219
    v_exp_f32 v220, v220
    v_smfmac_f32_32x32x32_bf16 v[224:239], v[72:75], v[208:215], v244
    v_exp_f32 v221, v221
    v_exp_f32 v222, v222
    v_exp_f32 v223, v223
    v_exp_f32 v192, v192
    v_exp_f32 v193, v193
    v_smfmac_f32_32x32x32_bf16 v[224:239], v[76:79], v[216:223], v244
    v_exp_f32 v194, v194
    v_exp_f32 v195, v195
    v_exp_f32 v196, v196
    v_mfma_f32_32x32x16_bf16 v[208:223], v[12:15], v[240:243], -4.0
    v_exp_f32 v197, v197
    v_exp_f32 v198, v198
    v_exp_f32 v199, v199
    v_exp_f32 v200, v200
    v_exp_f32 v201, v201
    v_exp_f32 v202, v202
    v_exp_f32 v203, v203
    v_exp_f32 v204, v204
    v_exp_f32 v205, v205
    v_exp_f32 v206, v206
    v_smfmac_f32_32x32x32_bf16 v[224:239], v[80:83], v[192:199], v244
    v_exp_f32 v207, v207
    v_exp_f32 v208, v208
    v_exp_f32 v209, v209
    v_smfmac_f32_32x32x32_bf16 v[224:239], v[84:87], v[200:207], v244
    v_exp_f32 v210, v210
    v_exp_f32 v211, v211
    v_exp_f32 v212, v212
    v_mfma_f32_32x32x16_bf16 v[192:207], v[16:19], v[240:243], -4.0
    v_exp_f32 v213, v213
    v_exp_f32 v214, v214
    v_exp_f32 v215, v215
    v_exp_f32 v216, v216
    v_exp_f32 v217, v217
    v_exp_f32 v218, v218
    v_exp_f32 v219, v219
    v_exp_f32 v220, v220
    v_exp_f32 v221, v221
    v_exp_f32 v222, v222
    v_smfmac_f32_32x32x32_bf16 v[224:239], v[88:91], v[208:215], v244
    v_exp_f32 v223, v223
    v_exp_f32 v192, v192
    v_exp_f32 v193, v193
    v_smfmac_f32_32x32x32_bf16 v[224:239], v[92:95], v[216:223], v244
    v_exp_f32 v194, v194
    v_exp_f32 v195, v195
    v_exp_f32 v196, v196
    v_mfma_f32_32x32x16_bf16 v[208:223], v[20:23], v[240:243], -4.0
    v_exp_f32 v197, v197
    v_exp_f32 v198, v198
    v_exp_f32 v199, v199
    v_exp_f32 v200, v200
    v_exp_f32 v201, v201
    v_exp_f32 v202, v202
    v_exp_f32 v203, v203
    v_exp_f32 v204, v204
    v_exp_f32 v205, v205
    v_exp_f32 v206, v206
    v_smfmac_f32_32x32x32_bf16 v[224:239], v[96:99], v[192:199], v244
    v_exp_f32 v207, v207
    v_exp_f32 v208, v208
    v_exp_f32 v209, v209
    v_smfmac_f32_32x32x32_bf16 v[224:239], v[100:103], v[200:207], v244
    v_exp_f32 v210, v210
    v_exp_f32 v211, v211
    v_exp_f32 v212, v212
    v_mfma_f32_32x32x16_bf16 v[192:207], v[24:27], v[240:243], -4.0
    v_exp_f32 v213, v213
    v_exp_f32 v214, v214
    v_exp_f32 v215, v215
    v_exp_f32 v216, v216
    v_exp_f32 v217, v217
    v_exp_f32 v218, v218
    v_exp_f32 v219, v219
    v_exp_f32 v220, v220
    v_exp_f32 v221, v221
    v_exp_f32 v222, v222
    v_smfmac_f32_32x32x32_bf16 v[224:239], v[104:107], v[208:215], v244
    v_exp_f32 v223, v223
    v_exp_f32 v192, v192
    v_exp_f32 v193, v193
    v_smfmac_f32_32x32x32_bf16 v[224:239], v[108:111], v[216:223], v244
    v_exp_f32 v194, v194
    v_exp_f32 v195, v195
    v_exp_f32 v196, v196
    v_mfma_f32_32x32x16_bf16 v[208:223], v[28:31], v[240:243], -4.0
    v_exp_f32 v197, v197
    v_exp_f32 v198, v198
    v_exp_f32 v199, v199
    v_exp_f32 v200, v200
    v_exp_f32 v201, v201
    v_exp_f32 v202, v202
    v_exp_f32 v203, v203
    v_exp_f32 v204, v204
    v_exp_f32 v205, v205
    v_exp_f32 v206, v206
    v_smfmac_f32_32x32x32_bf16 v[224:239], v[112:115], v[192:199], v244
    v_exp_f32 v207, v207
    v_exp_f32 v208, v208
    v_exp_f32 v209, v209
    v_smfmac_f32_32x32x32_bf16 v[224:239], v[116:119], v[200:207], v244
    v_exp_f32 v210, v210
    v_exp_f32 v211, v211
    v_exp_f32 v212, v212
    v_mfma_f32_32x32x16_bf16 v[192:207], v[32:35], v[240:243], -4.0
    v_exp_f32 v213, v213
    v_exp_f32 v214, v214
    v_exp_f32 v215, v215
    v_exp_f32 v216, v216
    v_exp_f32 v217, v217
    v_exp_f32 v218, v218
    v_exp_f32 v219, v219
    v_exp_f32 v220, v220
    v_exp_f32 v221, v221
    v_exp_f32 v222, v222
    v_smfmac_f32_32x32x32_bf16 v[224:239], v[120:123], v[208:215], v244
    v_exp_f32 v223, v223
    v_exp_f32 v192, v192
    v_exp_f32 v193, v193
    v_smfmac_f32_32x32x32_bf16 v[224:239], v[124:127], v[216:223], v244
    v_exp_f32 v194, v194
    v_exp_f32 v195, v195
    v_exp_f32 v196, v196
    v_mfma_f32_32x32x16_bf16 v[208:223], v[36:39], v[240:243], -4.0
    v_exp_f32 v197, v197
    v_exp_f32 v198, v198
    v_exp_f32 v199, v199
    v_exp_f32 v200, v200
    v_exp_f32 v201, v201
    v_exp_f32 v202, v202
    v_exp_f32 v203, v203
    v_exp_f32 v204, v204
    v_exp_f32 v205, v205
    v_exp_f32 v206, v206
    v_smfmac_f32_32x32x32_bf16 v[224:239], v[128:131], v[192:199], v244
    v_exp_f32 v207, v207
    v_exp_f32 v208, v208
    v_exp_f32 v209, v209
    v_smfmac_f32_32x32x32_bf16 v[224:239], v[132:135], v[200:207], v244
    v_exp_f32 v210, v210
    v_exp_f32 v211, v211
    v_exp_f32 v212, v212
    v_mfma_f32_32x32x16_bf16 v[192:207], v[40:43], v[240:243], -4.0
    v_exp_f32 v213, v213
    v_exp_f32 v214, v214
    v_exp_f32 v215, v215
    v_exp_f32 v216, v216
    v_exp_f32 v217, v217
    v_exp_f32 v218, v218
    v_exp_f32 v219, v219
    v_exp_f32 v220, v220
    v_exp_f32 v221, v221
    v_exp_f32 v222, v222
    v_smfmac_f32_32x32x32_bf16 v[224:239], v[136:139], v[208:215], v244
    v_exp_f32 v223, v223
    v_exp_f32 v192, v192
    v_exp_f32 v193, v193
    v_smfmac_f32_32x32x32_bf16 v[224:239], v[140:143], v[216:223], v244
    v_exp_f32 v194, v194
    v_exp_f32 v195, v195
    v_exp_f32 v196, v196
    v_mfma_f32_32x32x16_bf16 v[208:223], v[44:47], v[240:243], -4.0
    v_exp_f32 v197, v197
    v_exp_f32 v198, v198
    v_exp_f32 v199, v199
    v_exp_f32 v200, v200
    v_exp_f32 v201, v201
    v_exp_f32 v202, v202
    v_exp_f32 v203, v203
    v_exp_f32 v204, v204
    v_exp_f32 v205, v205
    v_exp_f32 v206, v206
    v_smfmac_f32_32x32x32_bf16 v[224:239], v[144:147], v[192:199], v244
    v_exp_f32 v207, v207
    v_exp_f32 v208, v208
    v_exp_f32 v209, v209
    v_smfmac_f32_32x32x32_bf16 v[224:239], v[148:151], v[200:207], v244
    v_exp_f32 v210, v210
    v_exp_f32 v211, v211
    v_exp_f32 v212, v212
    v_mfma_f32_32x32x16_bf16 v[192:207], v[48:51], v[240:243], -4.0
    v_exp_f32 v213, v213
    v_exp_f32 v214, v214
    v_exp_f32 v215, v215
    v_exp_f32 v216, v216
    v_exp_f32 v217, v217
    v_exp_f32 v218, v218
    v_exp_f32 v219, v219
    v_exp_f32 v220, v220
    v_exp_f32 v221, v221
    v_exp_f32 v222, v222
    v_smfmac_f32_32x32x32_bf16 v[224:239], v[152:155], v[208:215], v244
    v_exp_f32 v223, v223
    v_exp_f32 v192, v192
    v_exp_f32 v193, v193
    v_smfmac_f32_32x32x32_bf16 v[224:239], v[156:159], v[216:223], v244
    v_exp_f32 v194, v194
    v_exp_f32 v195, v195
    v_exp_f32 v196, v196
    v_mfma_f32_32x32x16_bf16 v[208:223], v[52:55], v[240:243], -4.0
    v_exp_f32 v197, v197
    v_exp_f32 v198, v198
    v_exp_f32 v199, v199
    v_exp_f32 v200, v200
    v_exp_f32 v201, v201
    v_exp_f32 v202, v202
    v_exp_f32 v203, v203
    v_exp_f32 v204, v204
    v_exp_f32 v205, v205
    v_exp_f32 v206, v206
    v_smfmac_f32_32x32x32_bf16 v[224:239], v[160:163], v[192:199], v244
    v_exp_f32 v207, v207
    v_exp_f32 v208, v208
    v_exp_f32 v209, v209
    v_smfmac_f32_32x32x32_bf16 v[224:239], v[164:167], v[200:207], v244
    v_exp_f32 v210, v210
    v_exp_f32 v211, v211
    v_exp_f32 v212, v212
    v_mfma_f32_32x32x16_bf16 v[192:207], v[56:59], v[240:243], -4.0
    v_exp_f32 v213, v213
    v_exp_f32 v214, v214
    v_exp_f32 v215, v215
    v_exp_f32 v216, v216
    v_exp_f32 v217, v217
    v_exp_f32 v218, v218
    v_exp_f32 v219, v219
    v_exp_f32 v220, v220
    v_exp_f32 v221, v221
    v_exp_f32 v222, v222
    v_smfmac_f32_32x32x32_bf16 v[224:239], v[168:171], v[208:215], v244
    v_exp_f32 v223, v223
    v_exp_f32 v192, v192
    v_exp_f32 v193, v193
    v_smfmac_f32_32x32x32_bf16 v[224:239], v[172:175], v[216:223], v244
    v_exp_f32 v194, v194
    v_exp_f32 v195, v195
    v_exp_f32 v196, v196
    v_mfma_f32_32x32x16_bf16 v[208:223], v[60:63], v[240:243], -4.0
    v_exp_f32 v197, v197
    v_exp_f32 v198, v198
    v_add_u32 v247, s11, v251
    ds_read_b128 v[240:243], v247 offset:5120
    v_exp_f32 v199, v199
    v_exp_f32 v200, v200
    v_exp_f32 v201, v201
    v_exp_f32 v202, v202
    v_exp_f32 v203, v203
    v_exp_f32 v204, v204
    v_exp_f32 v205, v205
    v_exp_f32 v206, v206
    v_smfmac_f32_32x32x32_bf16 v[224:239], v[176:179], v[192:199], v244
    v_exp_f32 v207, v207
    v_exp_f32 v208, v208
    v_exp_f32 v209, v209
    v_smfmac_f32_32x32x32_bf16 v[224:239], v[180:183], v[200:207], v244
    v_exp_f32 v210, v210
    v_exp_f32 v211, v211
    v_exp_f32 v212, v212
    s_waitcnt lgkmcnt(0)
    v_mfma_f32_32x32x16_bf16 v[192:207], v[0:3], v[240:243], -4.0
    v_exp_f32 v213, v213
    v_exp_f32 v214, v214
    v_exp_f32 v215, v215
    v_exp_f32 v216, v216
    v_exp_f32 v217, v217
    v_exp_f32 v218, v218
    v_exp_f32 v219, v219
    v_exp_f32 v220, v220
    v_exp_f32 v221, v221
    v_exp_f32 v222, v222
    v_smfmac_f32_32x32x32_bf16 v[224:239], v[184:187], v[208:215], v244
    v_exp_f32 v223, v223
    v_exp_f32 v192, v192
    v_exp_f32 v193, v193
    v_smfmac_f32_32x32x32_bf16 v[224:239], v[188:191], v[216:223], v244
    v_exp_f32 v194, v194
    v_exp_f32 v195, v195
    v_exp_f32 v196, v196
    v_mfma_f32_32x32x16_bf16 v[208:223], v[4:7], v[240:243], -4.0
    v_exp_f32 v197, v197
    v_exp_f32 v198, v198
    v_exp_f32 v199, v199
    ds_write_b128 v245, v[224:227] offset:21504
    v_mov_b32 v233, 5
    ds_write_b128 v245, v[228:231] offset:22528
    ds_write_b64 v246, v[232:233] offset:3072
    v_add_u32 v246, s10, v248
    v_add_u32 v245, s12, v251
    ds_read_b64 v[232:233], v246 offset:1024
    ds_read_b128 v[224:227], v245 offset:13312
    ds_read_b128 v[228:231], v245 offset:14336
    v_exp_f32 v200, v200
    v_exp_f32 v201, v201
    v_exp_f32 v202, v202
    v_exp_f32 v203, v203
    v_exp_f32 v204, v204
    v_exp_f32 v205, v205
    v_exp_f32 v206, v206
    v_exp_f32 v207, v207
    v_exp_f32 v208, v208
    v_exp_f32 v209, v209
    v_exp_f32 v210, v210
    s_waitcnt lgkmcnt(0)
    v_cmp_gt_u32 vcc, 4, v233
    v_exp_f32 v211, v211
    s_cbranch_vccnz L_hw4
L_hd4:
    v_smfmac_f32_32x32x32_bf16 v[224:239], v[64:67], v[192:199], v244
    v_exp_f32 v212, v212
    v_exp_f32 v213, v213
    v_exp_f32 v214, v214
    v_smfmac_f32_32x32x32_bf16 v[224:239], v[68:71], v[200:207], v244
    v_exp_f32 v215, v215
    v_exp_f32 v216, v216
    v_exp_f32 v217, v217
    v_mfma_f32_32x32x16_bf16 v[192:207], v[8:11], v[240:243], -4.0
    v_exp_f32 v218, v218
    v_exp_f32 v219, v219
    v_exp_f32 v220, v220
    v_smfmac_f32_32x32x32_bf16 v[224:239], v[72:75], v[208:215], v244
    v_exp_f32 v221, v221
    v_exp_f32 v222, v222
    v_exp_f32 v223, v223
    v_exp_f32 v192, v192
    v_exp_f32 v193, v193
    v_smfmac_f32_32x32x32_bf16 v[224:239], v[76:79], v[216:223], v244
    v_exp_f32 v194, v194
    v_exp_f32 v195, v195
    v_exp_f32 v196, v196
    v_mfma_f32_32x32x16_bf16 v[208:223], v[12:15], v[240:243], -4.0
    v_exp_f32 v197, v197
    v_exp_f32 v198, v198
    v_exp_f32 v199, v199
    v_exp_f32 v200, v200
    v_exp_f32 v201, v201
    v_exp_f32 v202, v202
    v_exp_f32 v203, v203
    v_exp_f32 v204, v204
    v_exp_f32 v205, v205
    v_exp_f32 v206, v206
    v_smfmac_f32_32x32x32_bf16 v[224:239], v[80:83], v[192:199], v244
    v_exp_f32 v207, v207
    v_exp_f32 v208, v208
    v_exp_f32 v209, v209
    v_smfmac_f32_32x32x32_bf16 v[224:239], v[84:87], v[200:207], v244
    v_exp_f32 v210, v210
    v_exp_f32 v211, v211
    v_exp_f32 v212, v212
    v_mfma_f32_32x32x16_bf16 v[192:207], v[16:19], v[240:243], -4.0
    v_exp_f32 v213, v213
    v_exp_f32 v214, v214
    v_exp_f32 v215, v215
    v_exp_f32 v216, v216
    v_exp_f32 v217, v217
    v_exp_f32 v218, v218
    v_exp_f32 v219, v219
    v_exp_f32 v220, v220
    v_exp_f32 v221, v221
    v_exp_f32 v222, v222
    v_smfmac_f32_32x32x32_bf16 v[224:239], v[88:91], v[208:215], v244
    v_exp_f32 v223, v223
    v_exp_f32 v192, v192
    v_exp_f32 v193, v193
    v_smfmac_f32_32x32x32_bf16 v[224:239], v[92:95], v[216:223], v244
    v_exp_f32 v194, v194
    v_exp_f32 v195, v195
    v_exp_f32 v196, v196
    v_mfma_f32_32x32x16_bf16 v[208:223], v[20:23], v[240:243], -4.0
    v_exp_f32 v197, v197
    v_exp_f32 v198, v198
    v_exp_f32 v199, v199
    v_exp_f32 v200, v200
    v_exp_f32 v201, v201
    v_exp_f32 v202, v202
    v_exp_f32 v203, v203
    v_exp_f32 v204, v204
    v_exp_f32 v205, v205
    v_exp_f32 v206, v206
    v_smfmac_f32_32x32x32_bf16 v[224:239], v[96:99], v[192:199], v244
    v_exp_f32 v207, v207
    v_exp_f32 v208, v208
    v_exp_f32 v209, v209
    v_smfmac_f32_32x32x32_bf16 v[224:239], v[100:103], v[200:207], v244
    v_exp_f32 v210, v210
    v_exp_f32 v211, v211
    v_exp_f32 v212, v212
    v_mfma_f32_32x32x16_bf16 v[192:207], v[24:27], v[240:243], -4.0
    v_exp_f32 v213, v213
    v_exp_f32 v214, v214
    v_exp_f32 v215, v215
    v_exp_f32 v216, v216
    v_exp_f32 v217, v217
    v_exp_f32 v218, v218
    v_exp_f32 v219, v219
    v_exp_f32 v220, v220
    v_exp_f32 v221, v221
    v_exp_f32 v222, v222
    v_smfmac_f32_32x32x32_bf16 v[224:239], v[104:107], v[208:215], v244
    v_exp_f32 v223, v223
    v_exp_f32 v192, v192
    v_exp_f32 v193, v193
    v_smfmac_f32_32x32x32_bf16 v[224:239], v[108:111], v[216:223], v244
    v_exp_f32 v194, v194
    v_exp_f32 v195, v195
    v_exp_f32 v196, v196
    v_mfma_f32_32x32x16_bf16 v[208:223], v[28:31], v[240:243], -4.0
    v_exp_f32 v197, v197
    v_exp_f32 v198, v198
    v_exp_f32 v199, v199
    v_exp_f32 v200, v200
    v_exp_f32 v201, v201
    v_exp_f32 v202, v202
    v_exp_f32 v203, v203
    v_exp_f32 v204, v204
    v_exp_f32 v205, v205
    v_exp_f32 v206, v206
    v_smfmac_f32_32x32x32_bf16 v[224:239], v[112:115], v[192:199], v244
    v_exp_f32 v207, v207
    v_exp_f32 v208, v208
    v_exp_f32 v209, v209
    v_smfmac_f32_32x32x32_bf16 v[224:239], v[116:119], v[200:207], v244
    v_exp_f32 v210, v210
    v_exp_f32 v211, v211
    v_exp_f32 v212, v212
    v_mfma_f32_32x32x16_bf16 v[192:207], v[32:35], v[240:243], -4.0
    v_exp_f32 v213, v213
    v_exp_f32 v214, v214
    v_exp_f32 v215, v215
    v_exp_f32 v216, v216
    v_exp_f32 v217, v217
    v_exp_f32 v218, v218
    v_exp_f32 v219, v219
    v_exp_f32 v220, v220
    v_exp_f32 v221, v221
    v_exp_f32 v222, v222
    v_smfmac_f32_32x32x32_bf16 v[224:239], v[120:123], v[208:215], v244
    v_exp_f32 v223, v223
    v_exp_f32 v192, v192
    v_exp_f32 v193, v193
    v_smfmac_f32_32x32x32_bf16 v[224:239], v[124:127], v[216:223], v244
    v_exp_f32 v194, v194
    v_exp_f32 v195, v195
    v_exp_f32 v196, v196
    v_mfma_f32_32x32x16_bf16 v[208:223], v[36:39], v[240:243], -4.0
    v_exp_f32 v197, v197
    v_exp_f32 v198, v198
    v_exp_f32 v199, v199
    v_exp_f32 v200, v200
    v_exp_f32 v201, v201
    v_exp_f32 v202, v202
    v_exp_f32 v203, v203
    v_exp_f32 v204, v204
    v_exp_f32 v205, v205
    v_exp_f32 v206, v206
    v_smfmac_f32_32x32x32_bf16 v[224:239], v[128:131], v[192:199], v244
    v_exp_f32 v207, v207
    v_exp_f32 v208, v208
    v_exp_f32 v209, v209
    v_smfmac_f32_32x32x32_bf16 v[224:239], v[132:135], v[200:207], v244
    v_exp_f32 v210, v210
    v_exp_f32 v211, v211
    v_exp_f32 v212, v212
    v_mfma_f32_32x32x16_bf16 v[192:207], v[40:43], v[240:243], -4.0
    v_exp_f32 v213, v213
    v_exp_f32 v214, v214
    v_exp_f32 v215, v215
    v_exp_f32 v216, v216
    v_exp_f32 v217, v217
    v_exp_f32 v218, v218
    v_exp_f32 v219, v219
    v_exp_f32 v220, v220
    v_exp_f32 v221, v221
    v_exp_f32 v222, v222
    v_smfmac_f32_32x32x32_bf16 v[224:239], v[136:139], v[208:215], v244
    v_exp_f32 v223, v223
    v_exp_f32 v192, v192
    v_exp_f32 v193, v193
    v_smfmac_f32_32x32x32_bf16 v[224:239], v[140:143], v[216:223], v244
    v_exp_f32 v194, v194
    v_exp_f32 v195, v195
    v_exp_f32 v196, v196
    v_mfma_f32_32x32x16_bf16 v[208:223], v[44:47], v[240:243], -4.0
    v_exp_f32 v197, v197
    v_exp_f32 v198, v198
    v_exp_f32 v199, v199
    v_exp_f32 v200, v200
    v_exp_f32 v201, v201
    v_exp_f32 v202, v202
    v_exp_f32 v203, v203
    v_exp_f32 v204, v204
    v_exp_f32 v205, v205
    v_exp_f32 v206, v206
    v_smfmac_f32_32x32x32_bf16 v[224:239], v[144:147], v[192:199], v244
    v_exp_f32 v207, v207
    v_exp_f32 v208, v208
    v_exp_f32 v209, v209
    v_smfmac_f32_32x32x32_bf16 v[224:239], v[148:151], v[200:207], v244
    v_exp_f32 v210, v210
    v_exp_f32 v211, v211
    v_exp_f32 v212, v212
    v_mfma_f32_32x32x16_bf16 v[192:207], v[48:51], v[240:243], -4.0
    v_exp_f32 v213, v213
    v_exp_f32 v214, v214
    v_exp_f32 v215, v215
    v_exp_f32 v216, v216
    v_exp_f32 v217, v217
    v_exp_f32 v218, v218
    v_exp_f32 v219, v219
    v_exp_f32 v220, v220
    v_exp_f32 v221, v221
    v_exp_f32 v222, v222
    v_smfmac_f32_32x32x32_bf16 v[224:239], v[152:155], v[208:215], v244
    v_exp_f32 v223, v223
    v_exp_f32 v192, v192
    v_exp_f32 v193, v193
    v_smfmac_f32_32x32x32_bf16 v[224:239], v[156:159], v[216:223], v244
    v_exp_f32 v194, v194
    v_exp_f32 v195, v195
    v_exp_f32 v196, v196
    v_mfma_f32_32x32x16_bf16 v[208:223], v[52:55], v[240:243], -4.0
    v_exp_f32 v197, v197
    v_exp_f32 v198, v198
    v_exp_f32 v199, v199
    v_exp_f32 v200, v200
    v_exp_f32 v201, v201
    v_exp_f32 v202, v202
    v_exp_f32 v203, v203
    v_exp_f32 v204, v204
    v_exp_f32 v205, v205
    v_exp_f32 v206, v206
    v_smfmac_f32_32x32x32_bf16 v[224:239], v[160:163], v[192:199], v244
    v_exp_f32 v207, v207
    v_exp_f32 v208, v208
    v_exp_f32 v209, v209
    v_smfmac_f32_32x32x32_bf16 v[224:239], v[164:167], v[200:207], v244
    v_exp_f32 v210, v210
    v_exp_f32 v211, v211
    v_exp_f32 v212, v212
    v_mfma_f32_32x32x16_bf16 v[192:207], v[56:59], v[240:243], -4.0
    v_exp_f32 v213, v213
    v_exp_f32 v214, v214
    v_exp_f32 v215, v215
    v_exp_f32 v216, v216
    v_exp_f32 v217, v217
    v_exp_f32 v218, v218
    v_exp_f32 v219, v219
    v_exp_f32 v220, v220
    v_exp_f32 v221, v221
    v_exp_f32 v222, v222
    v_smfmac_f32_32x32x32_bf16 v[224:239], v[168:171], v[208:215], v244
    v_exp_f32 v223, v223
    v_exp_f32 v192, v192
    v_exp_f32 v193, v193
    v_smfmac_f32_32x32x32_bf16 v[224:239], v[172:175], v[216:223], v244
    v_exp_f32 v194, v194
    v_exp_f32 v195, v195
    v_exp_f32 v196, v196
    v_mfma_f32_32x32x16_bf16 v[208:223], v[60:63], v[240:243], -4.0
    v_exp_f32 v197, v197
    v_exp_f32 v198, v198
    ds_read_b128 v[240:243], v247 offset:9216
    v_exp_f32 v199, v199
    v_exp_f32 v200, v200
    v_exp_f32 v201, v201
    v_exp_f32 v202, v202
    v_exp_f32 v203, v203
    v_exp_f32 v204, v204
    v_exp_f32 v205, v205
    v_exp_f32 v206, v206
    v_smfmac_f32_32x32x32_bf16 v[224:239], v[176:179], v[192:199], v244
    v_exp_f32 v207, v207
    v_exp_f32 v208, v208
    v_exp_f32 v209, v209
    v_smfmac_f32_32x32x32_bf16 v[224:239], v[180:183], v[200:207], v244
    v_exp_f32 v210, v210
    v_exp_f32 v211, v211
    v_exp_f32 v212, v212
    s_waitcnt lgkmcnt(0)
    v_mfma_f32_32x32x16_bf16 v[192:207], v[0:3], v[240:243], -4.0
    v_exp_f32 v213, v213
    v_exp_f32 v214, v214
    v_exp_f32 v215, v215
    v_exp_f32 v216, v216
    v_exp_f32 v217, v217
    v_exp_f32 v218, v218
    v_exp_f32 v219, v219
    v_exp_f32 v220, v220
    v_exp_f32 v221, v221
    v_exp_f32 v222, v222
    v_smfmac_f32_32x32x32_bf16 v[224:239], v[184:187], v[208:215], v244
    v_exp_f32 v223, v223
    v_exp_f32 v192, v192
    v_exp_f32 v193, v193
    v_smfmac_f32_32x32x32_bf16 v[224:239], v[188:191], v[216:223], v244
    v_exp_f32 v194, v194
    v_exp_f32 v195, v195
    v_exp_f32 v196, v196
    v_mfma_f32_32x32x16_bf16 v[208:223], v[4:7], v[240:243], -4.0
    v_exp_f32 v197, v197
    v_exp_f32 v198, v198
    v_exp_f32 v199, v199
    ds_write_b128 v245, v[224:227] offset:13312
    v_mov_b32 v233, 6
    ds_write_b128 v245, v[228:231] offset:14336
    ds_write_b64 v246, v[232:233] offset:1024
    ds_read_b64 v[232:233], v246 offset:3072
    ds_read_b128 v[224:227], v245 offset:21504
    ds_read_b128 v[228:231], v245 offset:22528
    v_exp_f32 v200, v200
    v_exp_f32 v201, v201
    v_exp_f32 v202, v202
    v_exp_f32 v203, v203
    v_exp_f32 v204, v204
    v_exp_f32 v205, v205
    v_exp_f32 v206, v206
    v_exp_f32 v207, v207
    v_exp_f32 v208, v208
    v_exp_f32 v209, v209
    v_exp_f32 v210, v210
    s_waitcnt lgkmcnt(0)
    v_cmp_gt_u32 vcc, 5, v233
    v_exp_f32 v211, v211
    s_cbranch_vccnz L_hw5
L_hd5:
    v_smfmac_f32_32x32x32_bf16 v[224:239], v[64:67], v[192:199], v244
    v_exp_f32 v212, v212
    v_exp_f32 v213, v213
    v_exp_f32 v214, v214
    v_smfmac_f32_32x32x32_bf16 v[224:239], v[68:71], v[200:207], v244
    v_exp_f32 v215, v215
    v_exp_f32 v216, v216
    v_exp_f32 v217, v217
    v_mfma_f32_32x32x16_bf16 v[192:207], v[8:11], v[240:243], -4.0
    v_exp_f32 v218, v218
    v_exp_f32 v219, v219
    v_exp_f32 v220, v220
    v_smfmac_f32_32x32x32_bf16 v[224:239], v[72:75], v[208:215], v244
    v_exp_f32 v221, v221
    v_exp_f32 v222, v222
    v_exp_f32 v223, v223
    v_exp_f32 v192, v192
    v_exp_f32 v193, v193
    v_smfmac_f32_32x32x32_bf16 v[224:239], v[76:79], v[216:223], v244
    v_exp_f32 v194, v194
    v_exp_f32 v195, v195
    v_exp_f32 v196, v196
    v_mfma_f32_32x32x16_bf16 v[208:223], v[12:15], v[240:243], -4.0
    v_exp_f32 v197, v197
    v_exp_f32 v198, v198
    v_exp_f32 v199, v199
    v_exp_f32 v200, v200
    v_exp_f32 v201, v201
    v_exp_f32 v202, v202
    v_exp_f32 v203, v203
    v_exp_f32 v204, v204
    v_exp_f32 v205, v205
    v_exp_f32 v206, v206
    v_smfmac_f32_32x32x32_bf16 v[224:239], v[80:83], v[192:199], v244
    v_exp_f32 v207, v207
    v_exp_f32 v208, v208
    v_exp_f32 v209, v209
    v_smfmac_f32_32x32x32_bf16 v[224:239], v[84:87], v[200:207], v244
    v_exp_f32 v210, v210
    v_exp_f32 v211, v211
    v_exp_f32 v212, v212
    v_mfma_f32_32x32x16_bf16 v[192:207], v[16:19], v[240:243], -4.0
    v_exp_f32 v213, v213
    v_exp_f32 v214, v214
    v_exp_f32 v215, v215
    v_exp_f32 v216, v216
    v_exp_f32 v217, v217
    v_exp_f32 v218, v218
    v_exp_f32 v219, v219
    v_exp_f32 v220, v220
    v_exp_f32 v221, v221
    v_exp_f32 v222, v222
    v_smfmac_f32_32x32x32_bf16 v[224:239], v[88:91], v[208:215], v244
    v_exp_f32 v223, v223
    v_exp_f32 v192, v192
    v_exp_f32 v193, v193
    v_smfmac_f32_32x32x32_bf16 v[224:239], v[92:95], v[216:223], v244
    v_exp_f32 v194, v194
    v_exp_f32 v195, v195
    v_exp_f32 v196, v196
    v_mfma_f32_32x32x16_bf16 v[208:223], v[20:23], v[240:243], -4.0
    v_exp_f32 v197, v197
    v_exp_f32 v198, v198
    v_exp_f32 v199, v199
    v_exp_f32 v200, v200
    v_exp_f32 v201, v201
    v_exp_f32 v202, v202
    v_exp_f32 v203, v203
    v_exp_f32 v204, v204
    v_exp_f32 v205, v205
    v_exp_f32 v206, v206
    v_smfmac_f32_32x32x32_bf16 v[224:239], v[96:99], v[192:199], v244
    v_exp_f32 v207, v207
    v_exp_f32 v208, v208
    v_exp_f32 v209, v209
    v_smfmac_f32_32x32x32_bf16 v[224:239], v[100:103], v[200:207], v244
    v_exp_f32 v210, v210
    v_exp_f32 v211, v211
    v_exp_f32 v212, v212
    v_mfma_f32_32x32x16_bf16 v[192:207], v[24:27], v[240:243], -4.0
    v_exp_f32 v213, v213
    v_exp_f32 v214, v214
    v_exp_f32 v215, v215
    v_exp_f32 v216, v216
    v_exp_f32 v217, v217
    v_exp_f32 v218, v218
    v_exp_f32 v219, v219
    v_exp_f32 v220, v220
    v_exp_f32 v221, v221
    v_exp_f32 v222, v222
    v_smfmac_f32_32x32x32_bf16 v[224:239], v[104:107], v[208:215], v244
    v_exp_f32 v223, v223
    v_exp_f32 v192, v192
    v_exp_f32 v193, v193
    v_smfmac_f32_32x32x32_bf16 v[224:239], v[108:111], v[216:223], v244
    v_exp_f32 v194, v194
    v_exp_f32 v195, v195
    v_exp_f32 v196, v196
    v_mfma_f32_32x32x16_bf16 v[208:223], v[28:31], v[240:243], -4.0
    v_exp_f32 v197, v197
    v_exp_f32 v198, v198
    v_exp_f32 v199, v199
    v_exp_f32 v200, v200
    v_exp_f32 v201, v201
    v_exp_f32 v202, v202
    v_exp_f32 v203, v203
    v_exp_f32 v204, v204
    v_exp_f32 v205, v205
    v_exp_f32 v206, v206
    v_smfmac_f32_32x32x32_bf16 v[224:239], v[112:115], v[192:199], v244
    v_exp_f32 v207, v207
    v_exp_f32 v208, v208
    v_exp_f32 v209, v209
    v_smfmac_f32_32x32x32_bf16 v[224:239], v[116:119], v[200:207], v244
    v_exp_f32 v210, v210
    v_exp_f32 v211, v211
    v_exp_f32 v212, v212
    v_mfma_f32_32x32x16_bf16 v[192:207], v[32:35], v[240:243], -4.0
    v_exp_f32 v213, v213
    v_exp_f32 v214, v214
    v_exp_f32 v215, v215
    v_exp_f32 v216, v216
    v_exp_f32 v217, v217
    v_exp_f32 v218, v218
    v_exp_f32 v219, v219
    v_exp_f32 v220, v220
    v_exp_f32 v221, v221
    v_exp_f32 v222, v222
    v_smfmac_f32_32x32x32_bf16 v[224:239], v[120:123], v[208:215], v244
    v_exp_f32 v223, v223
    v_exp_f32 v192, v192
    v_exp_f32 v193, v193
    v_smfmac_f32_32x32x32_bf16 v[224:239], v[124:127], v[216:223], v244
    v_exp_f32 v194, v194
    v_exp_f32 v195, v195
    v_exp_f32 v196, v196
    v_mfma_f32_32x32x16_bf16 v[208:223], v[36:39], v[240:243], -4.0
    v_exp_f32 v197, v197
    v_exp_f32 v198, v198
    v_exp_f32 v199, v199
    v_exp_f32 v200, v200
    v_exp_f32 v201, v201
    v_exp_f32 v202, v202
    v_exp_f32 v203, v203
    v_exp_f32 v204, v204
    v_exp_f32 v205, v205
    v_exp_f32 v206, v206
    v_smfmac_f32_32x32x32_bf16 v[224:239], v[128:131], v[192:199], v244
    v_exp_f32 v207, v207
    v_exp_f32 v208, v208
    v_exp_f32 v209, v209
    v_smfmac_f32_32x32x32_bf16 v[224:239], v[132:135], v[200:207], v244
    v_exp_f32 v210, v210
    v_exp_f32 v211, v211
    v_exp_f32 v212, v212
    v_mfma_f32_32x32x16_bf16 v[192:207], v[40:43], v[240:243], -4.0
    v_exp_f32 v213, v213
    v_exp_f32 v214, v214
    v_exp_f32 v215, v215
    v_exp_f32 v216, v216
    v_exp_f32 v217, v217
    v_exp_f32 v218, v218
    v_exp_f32 v219, v219
    v_exp_f32 v220, v220
    v_exp_f32 v221, v221
    v_exp_f32 v222, v222
    v_smfmac_f32_32x32x32_bf16 v[224:239], v[136:139], v[208:215], v244
    v_exp_f32 v223, v223
    v_exp_f32 v192, v192
    v_exp_f32 v193, v193
    v_smfmac_f32_32x32x32_bf16 v[224:239], v[140:143], v[216:223], v244
    v_exp_f32 v194, v194
    v_exp_f32 v195, v195
    v_exp_f32 v196, v196
    v_mfma_f32_32x32x16_bf16 v[208:223], v[44:47], v[240:243], -4.0
    v_exp_f32 v197, v197
    v_exp_f32 v198, v198
    v_exp_f32 v199, v199
    v_exp_f32 v200, v200
    v_exp_f32 v201, v201
    v_exp_f32 v202, v202
    v_exp_f32 v203, v203
    v_exp_f32 v204, v204
    v_exp_f32 v205, v205
    v_exp_f32 v206, v206
    v_smfmac_f32_32x32x32_bf16 v[224:239], v[144:147], v[192:199], v244
    v_exp_f32 v207, v207
    v_exp_f32 v208, v208
    v_exp_f32 v209, v209
    v_smfmac_f32_32x32x32_bf16 v[224:239], v[148:151], v[200:207], v244
    v_exp_f32 v210, v210
    v_exp_f32 v211, v211
    v_exp_f32 v212, v212
    v_mfma_f32_32x32x16_bf16 v[192:207], v[48:51], v[240:243], -4.0
    v_exp_f32 v213, v213
    v_exp_f32 v214, v214
    v_exp_f32 v215, v215
    v_exp_f32 v216, v216
    v_exp_f32 v217, v217
    v_exp_f32 v218, v218
    v_exp_f32 v219, v219
    v_exp_f32 v220, v220
    v_exp_f32 v221, v221
    v_exp_f32 v222, v222
    v_smfmac_f32_32x32x32_bf16 v[224:239], v[152:155], v[208:215], v244
    v_exp_f32 v223, v223
    v_exp_f32 v192, v192
    v_exp_f32 v193, v193
    v_smfmac_f32_32x32x32_bf16 v[224:239], v[156:159], v[216:223], v244
    v_exp_f32 v194, v194
    v_exp_f32 v195, v195
    v_exp_f32 v196, v196
    v_mfma_f32_32x32x16_bf16 v[208:223], v[52:55], v[240:243], -4.0
    v_exp_f32 v197, v197
    v_exp_f32 v198, v198
    v_exp_f32 v199, v199
    v_exp_f32 v200, v200
    v_exp_f32 v201, v201
    v_exp_f32 v202, v202
    v_exp_f32 v203, v203
    v_exp_f32 v204, v204
    v_exp_f32 v205, v205
    v_exp_f32 v206, v206
    v_smfmac_f32_32x32x32_bf16 v[224:239], v[160:163], v[192:199], v244
    v_exp_f32 v207, v207
    v_exp_f32 v208, v208
    v_exp_f32 v209, v209
    v_smfmac_f32_32x32x32_bf16 v[224:239], v[164:167], v[200:207], v244
    v_exp_f32 v210, v210
    v_exp_f32 v211, v211
    v_exp_f32 v212, v212
    v_mfma_f32_32x32x16_bf16 v[192:207], v[56:59], v[240:243], -4.0
    v_exp_f32 v213, v213
    v_exp_f32 v214, v214
    v_exp_f32 v215, v215
    v_exp_f32 v216, v216
    v_exp_f32 v217, v217
    v_exp_f32 v218, v218
    v_exp_f32 v219, v219
    v_exp_f32 v220, v220
    v_exp_f32 v221, v221
    v_exp_f32 v222, v222
    v_smfmac_f32_32x32x32_bf16 v[224:239], v[168:171], v[208:215], v244
    v_exp_f32 v223, v223
    v_exp_f32 v192, v192
    v_exp_f32 v193, v193
    v_smfmac_f32_32x32x32_bf16 v[224:239], v[172:175], v[216:223], v244
    v_exp_f32 v194, v194
    v_exp_f32 v195, v195
    v_exp_f32 v196, v196
    v_mfma_f32_32x32x16_bf16 v[208:223], v[60:63], v[240:243], -4.0
    v_exp_f32 v197, v197
    v_exp_f32 v198, v198
    v_add_u32 v247, s73, v251
    ds_read_b128 v[240:243], v247 offset:5120
    v_exp_f32 v199, v199
    v_exp_f32 v200, v200
    v_exp_f32 v201, v201
    v_exp_f32 v202, v202
    v_exp_f32 v203, v203
    v_exp_f32 v204, v204
    v_exp_f32 v205, v205
    v_exp_f32 v206, v206
    v_smfmac_f32_32x32x32_bf16 v[224:239], v[176:179], v[192:199], v244
    v_exp_f32 v207, v207
    v_exp_f32 v208, v208
    v_exp_f32 v209, v209
    v_smfmac_f32_32x32x32_bf16 v[224:239], v[180:183], v[200:207], v244
    v_exp_f32 v210, v210
    v_exp_f32 v211, v211
    v_exp_f32 v212, v212
    s_waitcnt lgkmcnt(0)
    v_mfma_f32_32x32x16_bf16 v[192:207], v[0:3], v[240:243], -4.0
    v_exp_f32 v213, v213
    v_exp_f32 v214, v214
    v_exp_f32 v215, v215
    v_exp_f32 v216, v216
    v_exp_f32 v217, v217
    v_exp_f32 v218, v218
    v_exp_f32 v219, v219
    v_exp_f32 v220, v220
    v_exp_f32 v221, v221
    v_exp_f32 v222, v222
    v_smfmac_f32_32x32x32_bf16 v[224:239], v[184:187], v[208:215], v244
    v_exp_f32 v223, v223
    v_exp_f32 v192, v192
    v_exp_f32 v193, v193
    v_smfmac_f32_32x32x32_bf16 v[224:239], v[188:191], v[216:223], v244
    v_exp_f32 v194, v194
    v_exp_f32 v195, v195
    v_exp_f32 v196, v196
    v_mfma_f32_32x32x16_bf16 v[208:223], v[4:7], v[240:243], -4.0
    v_exp_f32 v197, v197
    v_exp_f32 v198, v198
    v_exp_f32 v199, v199
    ds_write_b128 v245, v[224:227] offset:21504
    v_mov_b32 v233, 7
    ds_write_b128 v245, v[228:231] offset:22528
    ds_write_b64 v246, v[232:233] offset:3072
    v_add_u32 v246, s14, v248
    v_add_u32 v245, s74, v251
    ds_read_b64 v[232:233], v246 offset:1024
    ds_read_b128 v[224:227], v245 offset:13312
    ds_read_b128 v[228:231], v245 offset:14336
    v_exp_f32 v200, v200
    v_exp_f32 v201, v201
    v_exp_f32 v202, v202
    v_exp_f32 v203, v203
    v_exp_f32 v204, v204
    v_exp_f32 v205, v205
    v_exp_f32 v206, v206
    v_exp_f32 v207, v207
    v_exp_f32 v208, v208
    v_exp_f32 v209, v209
    v_exp_f32 v210, v210
    s_waitcnt lgkmcnt(0)
    v_cmp_gt_u32 vcc, 6, v233
    v_exp_f32 v211, v211
    s_cbranch_vccnz L_hw6
L_hd6:
    v_smfmac_f32_32x32x32_bf16 v[224:239], v[64:67], v[192:199], v244
    v_exp_f32 v212, v212
    v_exp_f32 v213, v213
    v_exp_f32 v214, v214
    v_smfmac_f32_32x32x32_bf16 v[224:239], v[68:71], v[200:207], v244
    v_exp_f32 v215, v215
    v_exp_f32 v216, v216
    v_exp_f32 v217, v217
    v_mfma_f32_32x32x16_bf16 v[192:207], v[8:11], v[240:243], -4.0
    v_exp_f32 v218, v218
    v_exp_f32 v219, v219
    v_exp_f32 v220, v220
    v_smfmac_f32_32x32x32_bf16 v[224:239], v[72:75], v[208:215], v244
    v_exp_f32 v221, v221
    v_exp_f32 v222, v222
    v_exp_f32 v223, v223
    v_exp_f32 v192, v192
    v_exp_f32 v193, v193
    v_smfmac_f32_32x32x32_bf16 v[224:239], v[76:79], v[216:223], v244
    v_exp_f32 v194, v194
    v_exp_f32 v195, v195
    v_exp_f32 v196, v196
    v_mfma_f32_32x32x16_bf16 v[208:223], v[12:15], v[240:243], -4.0
    v_exp_f32 v197, v197
    v_exp_f32 v198, v198
    v_exp_f32 v199, v199
    v_exp_f32 v200, v200
    v_exp_f32 v201, v201
    v_exp_f32 v202, v202
    v_exp_f32 v203, v203
    v_exp_f32 v204, v204
    v_exp_f32 v205, v205
    v_exp_f32 v206, v206
    v_smfmac_f32_32x32x32_bf16 v[224:239], v[80:83], v[192:199], v244
    v_exp_f32 v207, v207
    v_exp_f32 v208, v208
    v_exp_f32 v209, v209
    v_smfmac_f32_32x32x32_bf16 v[224:239], v[84:87], v[200:207], v244
    v_exp_f32 v210, v210
    v_exp_f32 v211, v211
    v_exp_f32 v212, v212
    v_mfma_f32_32x32x16_bf16 v[192:207], v[16:19], v[240:243], -4.0
    v_exp_f32 v213, v213
    v_exp_f32 v214, v214
    v_exp_f32 v215, v215
    v_exp_f32 v216, v216
    v_exp_f32 v217, v217
    v_exp_f32 v218, v218
    v_exp_f32 v219, v219
    v_exp_f32 v220, v220
    v_exp_f32 v221, v221
    v_exp_f32 v222, v222
    v_smfmac_f32_32x32x32_bf16 v[224:239], v[88:91], v[208:215], v244
    v_exp_f32 v223, v223
    v_exp_f32 v192, v192
    v_exp_f32 v193, v193
    v_smfmac_f32_32x32x32_bf16 v[224:239], v[92:95], v[216:223], v244
    v_exp_f32 v194, v194
    v_exp_f32 v195, v195
    v_exp_f32 v196, v196
    v_mfma_f32_32x32x16_bf16 v[208:223], v[20:23], v[240:243], -4.0
    v_exp_f32 v197, v197
    v_exp_f32 v198, v198
    v_exp_f32 v199, v199
    v_exp_f32 v200, v200
    v_exp_f32 v201, v201
    v_exp_f32 v202, v202
    v_exp_f32 v203, v203
    v_exp_f32 v204, v204
    v_exp_f32 v205, v205
    v_exp_f32 v206, v206
    v_smfmac_f32_32x32x32_bf16 v[224:239], v[96:99], v[192:199], v244
    v_exp_f32 v207, v207
    v_exp_f32 v208, v208
    v_exp_f32 v209, v209
    v_smfmac_f32_32x32x32_bf16 v[224:239], v[100:103], v[200:207], v244
    v_exp_f32 v210, v210
    v_exp_f32 v211, v211
    v_exp_f32 v212, v212
    v_mfma_f32_32x32x16_bf16 v[192:207], v[24:27], v[240:243], -4.0
    v_exp_f32 v213, v213
    v_exp_f32 v214, v214
    v_exp_f32 v215, v215
    v_exp_f32 v216, v216
    v_exp_f32 v217, v217
    v_exp_f32 v218, v218
    v_exp_f32 v219, v219
    v_exp_f32 v220, v220
    v_exp_f32 v221, v221
    v_exp_f32 v222, v222
    v_smfmac_f32_32x32x32_bf16 v[224:239], v[104:107], v[208:215], v244
    v_exp_f32 v223, v223
    v_exp_f32 v192, v192
    v_exp_f32 v193, v193
    v_smfmac_f32_32x32x32_bf16 v[224:239], v[108:111], v[216:223], v244
    v_exp_f32 v194, v194
    v_exp_f32 v195, v195
    v_exp_f32 v196, v196
    v_mfma_f32_32x32x16_bf16 v[208:223], v[28:31], v[240:243], -4.0
    v_exp_f32 v197, v197
    v_exp_f32 v198, v198
    v_exp_f32 v199, v199
    v_exp_f32 v200, v200
    v_exp_f32 v201, v201
    v_exp_f32 v202, v202
    v_exp_f32 v203, v203
    v_exp_f32 v204, v204
    v_exp_f32 v205, v205
    v_exp_f32 v206, v206
    v_smfmac_f32_32x32x32_bf16 v[224:239], v[112:115], v[192:199], v244
    v_exp_f32 v207, v207
    v_exp_f32 v208, v208
    v_exp_f32 v209, v209
    v_smfmac_f32_32x32x32_bf16 v[224:239], v[116:119], v[200:207], v244
    v_exp_f32 v210, v210
    v_exp_f32 v211, v211
    v_exp_f32 v212, v212
    v_mfma_f32_32x32x16_bf16 v[192:207], v[32:35], v[240:243], -4.0
    v_exp_f32 v213, v213
    v_exp_f32 v214, v214
    v_exp_f32 v215, v215
    v_exp_f32 v216, v216
    v_exp_f32 v217, v217
    v_exp_f32 v218, v218
    v_exp_f32 v219, v219
    v_exp_f32 v220, v220
    v_exp_f32 v221, v221
    v_exp_f32 v222, v222
    v_smfmac_f32_32x32x32_bf16 v[224:239], v[120:123], v[208:215], v244
    v_exp_f32 v223, v223
    v_exp_f32 v192, v192
    v_exp_f32 v193, v193
    v_smfmac_f32_32x32x32_bf16 v[224:239], v[124:127], v[216:223], v244
    v_exp_f32 v194, v194
    v_exp_f32 v195, v195
    v_exp_f32 v196, v196
    v_mfma_f32_32x32x16_bf16 v[208:223], v[36:39], v[240:243], -4.0
    v_exp_f32 v197, v197
    v_exp_f32 v198, v198
    v_exp_f32 v199, v199
    v_exp_f32 v200, v200
    v_exp_f32 v201, v201
    v_exp_f32 v202, v202
    v_exp_f32 v203, v203
    v_exp_f32 v204, v204
    v_exp_f32 v205, v205
    v_exp_f32 v206, v206
    v_smfmac_f32_32x32x32_bf16 v[224:239], v[128:131], v[192:199], v244
    v_exp_f32 v207, v207
    v_exp_f32 v208, v208
    v_exp_f32 v209, v209
    v_smfmac_f32_32x32x32_bf16 v[224:239], v[132:135], v[200:207], v244
    v_exp_f32 v210, v210
    v_exp_f32 v211, v211
    v_exp_f32 v212, v212
    v_mfma_f32_32x32x16_bf16 v[192:207], v[40:43], v[240:243], -4.0
    v_exp_f32 v213, v213
    v_exp_f32 v214, v214
    v_exp_f32 v215, v215
    v_exp_f32 v216, v216
    v_exp_f32 v217, v217
    v_exp_f32 v218, v218
    v_exp_f32 v219, v219
    v_exp_f32 v220, v220
    v_exp_f32 v221, v221
    v_exp_f32 v222, v222
    v_smfmac_f32_32x32x32_bf16 v[224:239], v[136:139], v[208:215], v244
    v_exp_f32 v223, v223
    v_exp_f32 v192, v192
    v_exp_f32 v193, v193
    v_smfmac_f32_32x32x32_bf16 v[224:239], v[140:143], v[216:223], v244
    v_exp_f32 v194, v194
    v_exp_f32 v195, v195
    v_exp_f32 v196, v196
    v_mfma_f32_32x32x16_bf16 v[208:223], v[44:47], v[240:243], -4.0
    v_exp_f32 v197, v197
    v_exp_f32 v198, v198
    v_exp_f32 v199, v199
    v_exp_f32 v200, v200
    v_exp_f32 v201, v201
    v_exp_f32 v202, v202
    v_exp_f32 v203, v203
    v_exp_f32 v204, v204
    v_exp_f32 v205, v205
    v_exp_f32 v206, v206
    v_smfmac_f32_32x32x32_bf16 v[224:239], v[144:147], v[192:199], v244
    v_exp_f32 v207, v207
    v_exp_f32 v208, v208
    v_exp_f32 v209, v209
    v_smfmac_f32_32x32x32_bf16 v[224:239], v[148:151], v[200:207], v244
    v_exp_f32 v210, v210
    v_exp_f32 v211, v211
    v_exp_f32 v212, v212
    v_mfma_f32_32x32x16_bf16 v[192:207], v[48:51], v[240:243], -4.0
    v_exp_f32 v213, v213
    v_exp_f32 v214, v214
    v_exp_f32 v215, v215
    v_exp_f32 v216, v216
    v_exp_f32 v217, v217
    v_exp_f32 v218, v218
    v_exp_f32 v219, v219
    v_exp_f32 v220, v220
    v_exp_f32 v221, v221
    v_exp_f32 v222, v222
    v_smfmac_f32_32x32x32_bf16 v[224:239], v[152:155], v[208:215], v244
    v_exp_f32 v223, v223
    v_exp_f32 v192, v192
    v_exp_f32 v193, v193
    v_smfmac_f32_32x32x32_bf16 v[224:239], v[156:159], v[216:223], v244
    v_exp_f32 v194, v194
    v_exp_f32 v195, v195
    v_exp_f32 v196, v196
    v_mfma_f32_32x32x16_bf16 v[208:223], v[52:55], v[240:243], -4.0
    v_exp_f32 v197, v197
    v_exp_f32 v198, v198
    v_exp_f32 v199, v199
    v_exp_f32 v200, v200
    v_exp_f32 v201, v201
    v_exp_f32 v202, v202
    v_exp_f32 v203, v203
    v_exp_f32 v204, v204
    v_exp_f32 v205, v205
    v_exp_f32 v206, v206
    v_smfmac_f32_32x32x32_bf16 v[224:239], v[160:163], v[192:199], v244
    v_exp_f32 v207, v207
    v_exp_f32 v208, v208
    v_exp_f32 v209, v209
    v_smfmac_f32_32x32x32_bf16 v[224:239], v[164:167], v[200:207], v244
    v_exp_f32 v210, v210
    v_exp_f32 v211, v211
    v_exp_f32 v212, v212
    v_mfma_f32_32x32x16_bf16 v[192:207], v[56:59], v[240:243], -4.0
    v_exp_f32 v213, v213
    v_exp_f32 v214, v214
    v_exp_f32 v215, v215
    v_exp_f32 v216, v216
    v_exp_f32 v217, v217
    v_exp_f32 v218, v218
    v_exp_f32 v219, v219
    v_exp_f32 v220, v220
    v_exp_f32 v221, v221
    v_exp_f32 v222, v222
    v_smfmac_f32_32x32x32_bf16 v[224:239], v[168:171], v[208:215], v244
    v_exp_f32 v223, v223
    v_exp_f32 v192, v192
    v_exp_f32 v193, v193
    v_smfmac_f32_32x32x32_bf16 v[224:239], v[172:175], v[216:223], v244
    v_exp_f32 v194, v194
    v_exp_f32 v195, v195
    v_exp_f32 v196, v196
    v_mfma_f32_32x32x16_bf16 v[208:223], v[60:63], v[240:243], -4.0
    v_exp_f32 v197, v197
    v_exp_f32 v198, v198
    ds_read_b128 v[240:243], v247 offset:9216
    ds_read_b32 v249, v253 offset:288
    v_exp_f32 v199, v199
    v_exp_f32 v200, v200
    v_exp_f32 v201, v201
    v_exp_f32 v202, v202
    v_exp_f32 v203, v203
    v_exp_f32 v204, v204
    v_exp_f32 v205, v205
    v_exp_f32 v206, v206
    v_smfmac_f32_32x32x32_bf16 v[224:239], v[176:179], v[192:199], v244
    v_exp_f32 v207, v207
    v_exp_f32 v208, v208
    v_exp_f32 v209, v209
    v_smfmac_f32_32x32x32_bf16 v[224:239], v[180:183], v[200:207], v244
    v_exp_f32 v210, v210
    v_exp_f32 v211, v211
    v_exp_f32 v212, v212
    s_waitcnt lgkmcnt(0)
    v_mfma_f32_32x32x16_bf16 v[192:207], v[0:3], v[240:243], -4.0
    v_cmp_ne_u32 vcc, 1, v249
    v_exp_f32 v213, v213
    v_exp_f32 v214, v214
    s_cbranch_vccnz L_check6
L_checked6:
    v_exp_f32 v215, v215
    v_exp_f32 v216, v216
    v_exp_f32 v217, v217
    v_exp_f32 v218, v218
    v_exp_f32 v219, v219
    v_exp_f32 v220, v220
    v_exp_f32 v221, v221
    v_exp_f32 v222, v222
    v_smfmac_f32_32x32x32_bf16 v[224:239], v[184:187], v[208:215], v244
    v_exp_f32 v223, v223
    v_exp_f32 v192, v192
    v_exp_f32 v193, v193
    v_smfmac_f32_32x32x32_bf16 v[224:239], v[188:191], v[216:223], v244
    v_exp_f32 v194, v194
    v_exp_f32 v195, v195
    v_exp_f32 v196, v196
    v_mfma_f32_32x32x16_bf16 v[208:223], v[4:7], v[240:243], -4.0
    v_exp_f32 v197, v197
    v_exp_f32 v198, v198
    v_exp_f32 v199, v199
    v_rcp_f32 v232, v232
    s_add_u32 s9, s75, 0
    v_pk_mul_f32 v[224:225], v[232:233], v[224:225] op_sel:[0,0] op_sel_hi:[0,1]
    v_pk_mul_f32 v[226:227], v[232:233], v[226:227] op_sel:[0,0] op_sel_hi:[0,1]
    v_pk_mul_f32 v[228:229], v[232:233], v[228:229] op_sel:[0,0] op_sel_hi:[0,1]
    v_pk_mul_f32 v[230:231], v[232:233], v[230:231] op_sel:[0,0] op_sel_hi:[0,1]
    v_cvt_pk_bf16_f32 v224, v224, v225
    v_cvt_pk_bf16_f32 v225, v226, v227
    v_cvt_pk_bf16_f32 v226, v228, v229
    v_cvt_pk_bf16_f32 v227, v230, v231
    buffer_store_dwordx4 v[224:227], v251, s[64:67], s9 offen sc1
    ds_read_b64 v[232:233], v246 offset:3072
    ds_read_b128 v[224:227], v245 offset:21504
    ds_read_b128 v[228:231], v245 offset:22528
    v_exp_f32 v200, v200
    v_exp_f32 v201, v201
    v_exp_f32 v202, v202
    v_exp_f32 v203, v203
    v_exp_f32 v204, v204
    v_exp_f32 v205, v205
    v_exp_f32 v206, v206
    v_exp_f32 v207, v207
    v_exp_f32 v208, v208
    v_exp_f32 v209, v209
    v_exp_f32 v210, v210
    s_waitcnt lgkmcnt(0)
    v_cmp_gt_u32 vcc, 7, v233
    v_exp_f32 v211, v211
    s_cbranch_vccnz L_hw7
L_hd7:
    v_smfmac_f32_32x32x32_bf16 v[224:239], v[64:67], v[192:199], v244
    v_exp_f32 v212, v212
    v_exp_f32 v213, v213
    v_exp_f32 v214, v214
    v_smfmac_f32_32x32x32_bf16 v[224:239], v[68:71], v[200:207], v244
    v_exp_f32 v215, v215
    v_exp_f32 v216, v216
    v_exp_f32 v217, v217
    v_mfma_f32_32x32x16_bf16 v[192:207], v[8:11], v[240:243], -4.0
    v_exp_f32 v218, v218
    v_exp_f32 v219, v219
    v_exp_f32 v220, v220
    v_smfmac_f32_32x32x32_bf16 v[224:239], v[72:75], v[208:215], v244
    v_exp_f32 v221, v221
    v_exp_f32 v222, v222
    v_exp_f32 v223, v223
    v_exp_f32 v192, v192
    v_exp_f32 v193, v193
    v_smfmac_f32_32x32x32_bf16 v[224:239], v[76:79], v[216:223], v244
    v_exp_f32 v194, v194
    v_exp_f32 v195, v195
    v_exp_f32 v196, v196
    v_mfma_f32_32x32x16_bf16 v[208:223], v[12:15], v[240:243], -4.0
    v_exp_f32 v197, v197
    v_exp_f32 v198, v198
    v_exp_f32 v199, v199
    v_exp_f32 v200, v200
    v_exp_f32 v201, v201
    v_exp_f32 v202, v202
    v_exp_f32 v203, v203
    v_exp_f32 v204, v204
    v_exp_f32 v205, v205
    v_exp_f32 v206, v206
    v_smfmac_f32_32x32x32_bf16 v[224:239], v[80:83], v[192:199], v244
    v_exp_f32 v207, v207
    v_exp_f32 v208, v208
    v_exp_f32 v209, v209
    v_smfmac_f32_32x32x32_bf16 v[224:239], v[84:87], v[200:207], v244
    v_exp_f32 v210, v210
    v_exp_f32 v211, v211
    v_exp_f32 v212, v212
    v_mfma_f32_32x32x16_bf16 v[192:207], v[16:19], v[240:243], -4.0
    v_exp_f32 v213, v213
    v_exp_f32 v214, v214
    v_exp_f32 v215, v215
    v_exp_f32 v216, v216
    v_exp_f32 v217, v217
    v_exp_f32 v218, v218
    v_exp_f32 v219, v219
    v_exp_f32 v220, v220
    v_exp_f32 v221, v221
    v_exp_f32 v222, v222
    v_smfmac_f32_32x32x32_bf16 v[224:239], v[88:91], v[208:215], v244
    v_exp_f32 v223, v223
    v_exp_f32 v192, v192
    v_exp_f32 v193, v193
    v_smfmac_f32_32x32x32_bf16 v[224:239], v[92:95], v[216:223], v244
    v_exp_f32 v194, v194
    v_exp_f32 v195, v195
    v_exp_f32 v196, v196
    v_mfma_f32_32x32x16_bf16 v[208:223], v[20:23], v[240:243], -4.0
    v_exp_f32 v197, v197
    v_exp_f32 v198, v198
    v_exp_f32 v199, v199
    v_exp_f32 v200, v200
    v_exp_f32 v201, v201
    v_exp_f32 v202, v202
    v_exp_f32 v203, v203
    v_exp_f32 v204, v204
    v_exp_f32 v205, v205
    v_exp_f32 v206, v206
    v_smfmac_f32_32x32x32_bf16 v[224:239], v[96:99], v[192:199], v244
    v_exp_f32 v207, v207
    v_exp_f32 v208, v208
    v_exp_f32 v209, v209
    v_smfmac_f32_32x32x32_bf16 v[224:239], v[100:103], v[200:207], v244
    v_exp_f32 v210, v210
    v_exp_f32 v211, v211
    v_exp_f32 v212, v212
    v_mfma_f32_32x32x16_bf16 v[192:207], v[24:27], v[240:243], -4.0
    v_exp_f32 v213, v213
    v_exp_f32 v214, v214
    v_exp_f32 v215, v215
    v_exp_f32 v216, v216
    v_exp_f32 v217, v217
    v_exp_f32 v218, v218
    v_exp_f32 v219, v219
    v_exp_f32 v220, v220
    v_exp_f32 v221, v221
    v_exp_f32 v222, v222
    v_smfmac_f32_32x32x32_bf16 v[224:239], v[104:107], v[208:215], v244
    v_exp_f32 v223, v223
    v_exp_f32 v192, v192
    v_exp_f32 v193, v193
    v_smfmac_f32_32x32x32_bf16 v[224:239], v[108:111], v[216:223], v244
    v_exp_f32 v194, v194
    v_exp_f32 v195, v195
    v_exp_f32 v196, v196
    v_mfma_f32_32x32x16_bf16 v[208:223], v[28:31], v[240:243], -4.0
    v_exp_f32 v197, v197
    v_exp_f32 v198, v198
    v_exp_f32 v199, v199
    v_exp_f32 v200, v200
    v_exp_f32 v201, v201
    v_exp_f32 v202, v202
    v_exp_f32 v203, v203
    v_exp_f32 v204, v204
    v_exp_f32 v205, v205
    v_exp_f32 v206, v206
    v_smfmac_f32_32x32x32_bf16 v[224:239], v[112:115], v[192:199], v244
    v_exp_f32 v207, v207
    v_exp_f32 v208, v208
    v_exp_f32 v209, v209
    v_smfmac_f32_32x32x32_bf16 v[224:239], v[116:119], v[200:207], v244
    v_exp_f32 v210, v210
    v_exp_f32 v211, v211
    v_exp_f32 v212, v212
    v_mfma_f32_32x32x16_bf16 v[192:207], v[32:35], v[240:243], -4.0
    v_exp_f32 v213, v213
    v_exp_f32 v214, v214
    v_exp_f32 v215, v215
    v_exp_f32 v216, v216
    v_exp_f32 v217, v217
    v_exp_f32 v218, v218
    v_exp_f32 v219, v219
    v_exp_f32 v220, v220
    v_exp_f32 v221, v221
    v_exp_f32 v222, v222
    v_smfmac_f32_32x32x32_bf16 v[224:239], v[120:123], v[208:215], v244
    v_exp_f32 v223, v223
    v_exp_f32 v192, v192
    v_exp_f32 v193, v193
    v_smfmac_f32_32x32x32_bf16 v[224:239], v[124:127], v[216:223], v244
    v_exp_f32 v194, v194
    v_exp_f32 v195, v195
    v_exp_f32 v196, v196
    v_mfma_f32_32x32x16_bf16 v[208:223], v[36:39], v[240:243], -4.0
    v_exp_f32 v197, v197
    v_exp_f32 v198, v198
    v_exp_f32 v199, v199
    v_exp_f32 v200, v200
    v_exp_f32 v201, v201
    v_exp_f32 v202, v202
    v_exp_f32 v203, v203
    v_exp_f32 v204, v204
    v_exp_f32 v205, v205
    v_exp_f32 v206, v206
    v_smfmac_f32_32x32x32_bf16 v[224:239], v[128:131], v[192:199], v244
    v_exp_f32 v207, v207
    v_exp_f32 v208, v208
    v_exp_f32 v209, v209
    v_smfmac_f32_32x32x32_bf16 v[224:239], v[132:135], v[200:207], v244
    v_exp_f32 v210, v210
    v_exp_f32 v211, v211
    v_exp_f32 v212, v212
    v_mfma_f32_32x32x16_bf16 v[192:207], v[40:43], v[240:243], -4.0
    v_exp_f32 v213, v213
    v_exp_f32 v214, v214
    v_exp_f32 v215, v215
    v_exp_f32 v216, v216
    v_exp_f32 v217, v217
    v_exp_f32 v218, v218
    v_exp_f32 v219, v219
    v_exp_f32 v220, v220
    v_exp_f32 v221, v221
    v_exp_f32 v222, v222
    v_smfmac_f32_32x32x32_bf16 v[224:239], v[136:139], v[208:215], v244
    v_exp_f32 v223, v223
    v_exp_f32 v192, v192
    v_exp_f32 v193, v193
    v_smfmac_f32_32x32x32_bf16 v[224:239], v[140:143], v[216:223], v244
    v_exp_f32 v194, v194
    v_exp_f32 v195, v195
    v_exp_f32 v196, v196
    v_mfma_f32_32x32x16_bf16 v[208:223], v[44:47], v[240:243], -4.0
    v_exp_f32 v197, v197
    v_exp_f32 v198, v198
    v_exp_f32 v199, v199
    v_exp_f32 v200, v200
    v_exp_f32 v201, v201
    v_exp_f32 v202, v202
    v_exp_f32 v203, v203
    v_exp_f32 v204, v204
    v_exp_f32 v205, v205
    v_exp_f32 v206, v206
    v_smfmac_f32_32x32x32_bf16 v[224:239], v[144:147], v[192:199], v244
    v_exp_f32 v207, v207
    v_exp_f32 v208, v208
    v_exp_f32 v209, v209
    v_smfmac_f32_32x32x32_bf16 v[224:239], v[148:151], v[200:207], v244
    v_exp_f32 v210, v210
    v_exp_f32 v211, v211
    v_exp_f32 v212, v212
    v_mfma_f32_32x32x16_bf16 v[192:207], v[48:51], v[240:243], -4.0
    v_exp_f32 v213, v213
    v_exp_f32 v214, v214
    v_exp_f32 v215, v215
    v_exp_f32 v216, v216
    v_exp_f32 v217, v217
    v_exp_f32 v218, v218
    v_exp_f32 v219, v219
    v_exp_f32 v220, v220
    v_exp_f32 v221, v221
    v_exp_f32 v222, v222
    v_smfmac_f32_32x32x32_bf16 v[224:239], v[152:155], v[208:215], v244
    v_exp_f32 v223, v223
    v_exp_f32 v192, v192
    v_exp_f32 v193, v193
    v_smfmac_f32_32x32x32_bf16 v[224:239], v[156:159], v[216:223], v244
    v_exp_f32 v194, v194
    v_exp_f32 v195, v195
    v_exp_f32 v196, v196
    v_mfma_f32_32x32x16_bf16 v[208:223], v[52:55], v[240:243], -4.0
    v_exp_f32 v197, v197
    v_exp_f32 v198, v198
    v_exp_f32 v199, v199
    v_exp_f32 v200, v200
    v_exp_f32 v201, v201
    v_exp_f32 v202, v202
    v_exp_f32 v203, v203
    v_exp_f32 v204, v204
    v_exp_f32 v205, v205
    v_exp_f32 v206, v206
    v_smfmac_f32_32x32x32_bf16 v[224:239], v[160:163], v[192:199], v244
    v_exp_f32 v207, v207
    v_exp_f32 v208, v208
    v_exp_f32 v209, v209
    v_smfmac_f32_32x32x32_bf16 v[224:239], v[164:167], v[200:207], v244
    v_exp_f32 v210, v210
    v_exp_f32 v211, v211
    v_exp_f32 v212, v212
    v_mfma_f32_32x32x16_bf16 v[192:207], v[56:59], v[240:243], -4.0
    v_exp_f32 v213, v213
    v_exp_f32 v214, v214
    v_exp_f32 v215, v215
    v_exp_f32 v216, v216
    v_exp_f32 v217, v217
    v_exp_f32 v218, v218
    v_exp_f32 v219, v219
    v_exp_f32 v220, v220
    v_exp_f32 v221, v221
    v_exp_f32 v222, v222
    v_smfmac_f32_32x32x32_bf16 v[224:239], v[168:171], v[208:215], v244
    v_exp_f32 v223, v223
    v_exp_f32 v192, v192
    v_exp_f32 v193, v193
    v_smfmac_f32_32x32x32_bf16 v[224:239], v[172:175], v[216:223], v244
    v_exp_f32 v194, v194
    v_exp_f32 v195, v195
    v_exp_f32 v196, v196
    v_mfma_f32_32x32x16_bf16 v[208:223], v[60:63], v[240:243], -4.0
    v_exp_f32 v197, v197
    v_exp_f32 v198, v198
    v_exp_f32 v199, v199
    v_exp_f32 v200, v200
    v_exp_f32 v201, v201
    v_exp_f32 v202, v202
    v_exp_f32 v203, v203
    v_exp_f32 v204, v204
    v_exp_f32 v205, v205
    v_exp_f32 v206, v206
    v_smfmac_f32_32x32x32_bf16 v[224:239], v[176:179], v[192:199], v244
    v_exp_f32 v207, v207
    v_exp_f32 v208, v208
    v_exp_f32 v209, v209
    v_smfmac_f32_32x32x32_bf16 v[224:239], v[180:183], v[200:207], v244
    v_exp_f32 v210, v210
    v_exp_f32 v211, v211
    v_exp_f32 v212, v212
    v_exp_f32 v213, v213
    v_exp_f32 v214, v214
    v_exp_f32 v215, v215
    v_exp_f32 v216, v216
    v_exp_f32 v217, v217
    v_exp_f32 v218, v218
    v_exp_f32 v219, v219
    v_exp_f32 v220, v220
    v_exp_f32 v221, v221
    v_exp_f32 v222, v222
    v_smfmac_f32_32x32x32_bf16 v[224:239], v[184:187], v[208:215], v244
    v_exp_f32 v223, v223
    s_nop 0
    s_nop 0
    v_smfmac_f32_32x32x32_bf16 v[224:239], v[188:191], v[216:223], v244
    s_branch L_attn_epi
L_hw2:
    s_mov_b32 s15, 400000
L_hl2:
    s_sleep 1
    ds_read_b64 v[232:233], v246 offset:1024
    ds_read_b128 v[224:227], v245 offset:13312
    ds_read_b128 v[228:231], v245 offset:14336
    s_waitcnt lgkmcnt(0)
    v_cmp_gt_u32 vcc, 2, v233
    s_nop 0
    s_cbranch_vccz L_hd2
    s_sub_u32 s15, s15, 1
    s_cbranch_scc0 L_hl2
    s_branch L_hd2
L_hw3:
    s_mov_b32 s15, 400000
L_hl3:
    s_sleep 1
    ds_read_b64 v[232:233], v246 offset:3072
    ds_read_b128 v[224:227], v245 offset:21504
    ds_read_b128 v[228:231], v245 offset:22528
    s_waitcnt lgkmcnt(0)
    v_cmp_gt_u32 vcc, 3, v233
    s_nop 0
    s_cbranch_vccz L_hd3
    s_sub_u32 s15, s15, 1
    s_cbranch_scc0 L_hl3
    s_branch L_hd3
L_hw4:
    s_mov_b32 s15, 400000
L_hl4:
    s_sleep 1
    ds_read_b64 v[232:233], v246 offset:1024
    ds_read_b128 v[224:227], v245 offset:13312
    ds_read_b128 v[228:231], v245 offset:14336
    s_waitcnt lgkmcnt(0)
    v_cmp_gt_u32 vcc, 4, v233
    s_nop 0
    s_cbranch_vccz L_hd4
    s_sub_u32 s15, s15, 1
    s_cbranch_scc0 L_hl4
    s_branch L_hd4
L_hw5:
    s_mov_b32 s15, 400000
L_hl5:
    s_sleep 1
    ds_read_b64 v[232:233], v246 offset:3072
    ds_read_b128 v[224:227], v245 offset:21504
    ds_read_b128 v[228:231], v245 offset:22528
    s_waitcnt lgkmcnt(0)
    v_cmp_gt_u32 vcc, 5, v233
    s_nop 0
    s_cbranch_vccz L_hd5
    s_sub_u32 s15, s15, 1
    s_cbranch_scc0 L_hl5
    s_branch L_hd5
L_hw6:
    s_mov_b32 s15, 400000
L_hl6:
    s_sleep 1
    ds_read_b64 v[232:233], v246 offset:1024
    ds_read_b128 v[224:227], v245 offset:13312
    ds_read_b128 v[228:231], v245 offset:14336
    s_waitcnt lgkmcnt(0)
    v_cmp_gt_u32 vcc, 6, v233
    s_nop 0
    s_cbranch_vccz L_hd6
    s_sub_u32 s15, s15, 1
    s_cbranch_scc0 L_hl6
    s_branch L_hd6
L_hw7:
    s_mov_b32 s15, 400000
L_hl7:
    s_sleep 1
    ds_read_b64 v[232:233], v246 offset:3072
    ds_read_b128 v[224:227], v245 offset:21504
    ds_read_b128 v[228:231], v245 offset:22528
    s_waitcnt lgkmcnt(0)
    v_cmp_gt_u32 vcc, 7, v233
    s_nop 0
    s_cbranch_vccz L_hd7
    s_sub_u32 s15, s15, 1
    s_cbranch_scc0 L_hl7
    s_branch L_hd7
L_attn_epi:
    s_setprio 3
    ds_write_b32 v254, v255 offset:112
    ds_read_b32 v252, v253 offset:224
    v_lshrrev_b32 v241, 9, v251
    v_bfe_u32 v243, v251, 2, 7
    v_lshl_add_u32 v243, v241, 14, v243
    v_mov_b32 v240, 0
    v_mov_b32 v241, 0
    s_and_b32 s9, s75, 0xc00
    s_lshl_b32 s9, s9, 1
    v_add_u32 v242, s9, v251
    s_xor_b32 s9, s9, 0x1000
    v_add_u32 v245, s9, v251
    v_xor_b32 v246, 8, v254
    v_rcp_f32 v232, v232
    s_add_u32 s9, s75, 32768
    v_pk_mul_f32 v[224:225], v[232:233], v[224:225] op_sel:[0,0] op_sel_hi:[0,1]
    v_pk_mul_f32 v[226:227], v[232:233], v[226:227] op_sel:[0,0] op_sel_hi:[0,1]
    v_pk_mul_f32 v[228:229], v[232:233], v[228:229] op_sel:[0,0] op_sel_hi:[0,1]
    v_pk_mul_f32 v[230:231], v[232:233], v[230:231] op_sel:[0,0] op_sel_hi:[0,1]
    v_cvt_pk_bf16_f32 v224, v224, v225
    v_cvt_pk_bf16_f32 v225, v226, v227
    v_cvt_pk_bf16_f32 v226, v228, v229
    v_cvt_pk_bf16_f32 v227, v230, v231
    buffer_store_dwordx4 v[224:227], v251, s[64:67], s9 offen sc1
    ds_write_b32 v254, v255 offset:128
    v_mfma_f32_32x32x8_bf16 v[192:207], v[240:241], v[240:241], 0
    v_mfma_f32_32x32x8_bf16 v[208:223], v[240:241], v[240:241], 0
    s_mov_b32 s12, 0xff
    s_waitcnt lgkmcnt(0)
    v_cmp_eq_u32 vcc, 0, v252
    s_nop 0
    s_cbranch_vccz L_s5ok
    s_mov_b32 s15, 400000
W_37:
    ds_read_b32 v249, v253 offset:224
    s_waitcnt lgkmcnt(0)
    v_cmp_eq_u32 vcc, 0, v249
    s_nop 0
    s_cbranch_vccz WD_38
    s_sleep 1
    s_sub_u32 s15, s15, 1
    s_cbranch_scc0 W_37
WD_38:
L_s5ok:
L_xl:
    s_xor_b32 s9, s101, 0x1000
    buffer_load_dwordx4 v[104:107], v251, s[64:67], s9 offen offset:0 sc1
    buffer_load_dwordx4 v[108:111], v251, s[64:67], s9 offen offset:1024 sc1
    buffer_load_dwordx4 v[24:27], v251, s[64:67], s9 offen offset:2048 sc1
    buffer_load_dwordx4 v[112:115], v251, s[64:67], s9 offen offset:3072 sc1
    s_xor_b32 s9, s101, 0x2000
    buffer_load_dwordx4 v[116:119], v251, s[64:67], s9 offen offset:0 sc1
    buffer_load_dwordx4 v[28:31], v251, s[64:67], s9 offen offset:1024 sc1
    buffer_load_dwordx4 v[120:123], v251, s[64:67], s9 offen offset:2048 sc1
    buffer_load_dwordx4 v[124:127], v251, s[64:67], s9 offen offset:3072 sc1
    ds_read_b64_tr_b16 v[0:1], v250 offset:0
    ds_read_b64_tr_b16 v[2:3], v250 offset:1024
    ds_read_b64_tr_b16 v[64:65], v250 offset:2048
    ds_read_b64_tr_b16 v[66:67], v250 offset:3072
    ds_read_b64_tr_b16 v[68:69], v250 offset:4096
    ds_read_b64_tr_b16 v[70:71], v250 offset:5120
    ds_read_b64_tr_b16 v[4:5], v250 offset:6144
    ds_read_b64_tr_b16 v[6:7], v250 offset:7168
    ds_read_b64_tr_b16 v[72:73], v250 offset:8192
    ds_read_b64_tr_b16 v[74:75], v250 offset:9216
    ds_read_b64_tr_b16 v[76:77], v250 offset:10240
    ds_read_b64_tr_b16 v[78:79], v250 offset:11264
    ds_read_b64_tr_b16 v[8:9], v250 offset:12288
    ds_read_b64_tr_b16 v[10:11], v250 offset:13312
    ds_read_b64_tr_b16 v[80:81], v250 offset:14336
    ds_read_b64_tr_b16 v[82:83], v250 offset:15360
    ds_read_b64_tr_b16 v[84:85], v250 offset:16384
    ds_read_b64_tr_b16 v[86:87], v250 offset:17408
    ds_read_b64_tr_b16 v[12:13], v250 offset:18432
    ds_read_b64_tr_b16 v[14:15], v250 offset:19456
    ds_read_b64_tr_b16 v[88:89], v250 offset:20480
    ds_read_b64_tr_b16 v[90:91], v250 offset:21504
    ds_read_b64_tr_b16 v[92:93], v250 offset:22528
    ds_read_b64_tr_b16 v[94:95], v250 offset:23552
    ds_read_b64_tr_b16 v[16:17], v250 offset:24576
    ds_read_b64_tr_b16 v[18:19], v250 offset:25600
    ds_read_b64_tr_b16 v[96:97], v250 offset:26624
    ds_read_b64_tr_b16 v[98:99], v250 offset:27648
    ds_read_b64_tr_b16 v[100:101], v250 offset:28672
    ds_read_b64_tr_b16 v[102:103], v250 offset:29696
    ds_read_b64_tr_b16 v[20:21], v250 offset:30720
    ds_read_b64_tr_b16 v[22:23], v250 offset:31744
    s_mov_b32 s15, 400000
W_39:
    ds_read_b32 v249, v253 offset:128
    s_waitcnt lgkmcnt(0)
    v_cmp_eq_u32 vcc, 0, v249
    s_nop 0
    s_cbranch_vccz WD_40
    s_sub_u32 s15, s15, 1
    s_cbranch_scc0 W_39
WD_40:
    s_xor_b32 s9, s101, 0x3000
    buffer_load_dwordx4 v[32:35], v251, s[64:67], s9 offen offset:0 sc1
    buffer_load_dwordx4 v[128:131], v251, s[64:67], s9 offen offset:1024 sc1
    buffer_load_dwordx4 v[132:135], v251, s[64:67], s9 offen offset:2048 sc1
    buffer_load_dwordx4 v[36:39], v251, s[64:67], s9 offen offset:3072 sc1
    s_xor_b32 s9, s101, 0x0
    buffer_load_dwordx4 v[136:139], v251, s[64:67], s9 offen offset:0 sc1
    buffer_load_dwordx4 v[140:143], v251, s[64:67], s9 offen offset:1024 sc1
    buffer_load_dwordx4 v[40:43], v251, s[64:67], s9 offen offset:2048 sc1
    buffer_load_dwordx4 v[144:147], v251, s[64:67], s9 offen offset:3072 sc1
    s_waitcnt vmcnt(12)
    v_max3_u32 v249, v104, v105, v106
    v_max3_u32 v249, v107, v108, v249
    v_max3_u32 v249, v109, v110, v249
    v_max3_u32 v249, v111, v24, v249
    v_max3_u32 v249, v25, v26, v249
    v_max3_u32 v249, v27, v112, v249
    v_max3_u32 v249, v113, v114, v249
    v_max_u32 v249, v115, v249
    v_cmp_eq_u32 vcc, -1, v249
    s_nop 0
    s_cbranch_vccnz L_o0_1
    v_mfma_f32_32x32x16_bf16 v[192:207], v[104:107], v[72:75], v[192:207]
    v_mfma_f32_32x32x16_bf16 v[192:207], v[108:111], v[76:79], v[192:207]
    v_mfma_f32_32x32x16_bf16 v[192:207], v[24:27], v[8:11], v[192:207]
    v_mfma_f32_32x32x16_bf16 v[192:207], v[112:115], v[80:83], v[192:207]
    s_bitset0_b32 s12, 1
L_o0_1:
    s_waitcnt vmcnt(8)
    v_max3_u32 v249, v116, v117, v118
    v_max3_u32 v249, v119, v28, v249
    v_max3_u32 v249, v29, v30, v249
    v_max3_u32 v249, v31, v120, v249
    v_max3_u32 v249, v121, v122, v249
    v_max3_u32 v249, v123, v124, v249
    v_max3_u32 v249, v125, v126, v249
    v_max_u32 v249, v127, v249
    v_cmp_eq_u32 vcc, -1, v249
    s_nop 0
    s_cbranch_vccnz L_o0_2
    v_mfma_f32_32x32x16_bf16 v[192:207], v[116:119], v[84:87], v[192:207]
    v_mfma_f32_32x32x16_bf16 v[192:207], v[28:31], v[12:15], v[192:207]
    v_mfma_f32_32x32x16_bf16 v[192:207], v[120:123], v[88:91], v[192:207]
    v_mfma_f32_32x32x16_bf16 v[192:207], v[124:127], v[92:95], v[192:207]
    s_bitset0_b32 s12, 2
L_o0_2:
    s_waitcnt vmcnt(4)
    v_max3_u32 v249, v32, v33, v34
    v_max3_u32 v249, v35, v128, v249
    v_max3_u32 v249, v129, v130, v249
    v_max3_u32 v249, v131, v132, v249
    v_max3_u32 v249, v133, v134, v249
    v_max3_u32 v249, v135, v36, v249
    v_max3_u32 v249, v37, v38, v249
    v_max_u32 v249, v39, v249
    v_cmp_eq_u32 vcc, -1, v249
    s_nop 0
    s_cbranch_vccnz L_o0_3
    v_mfma_f32_32x32x16_bf16 v[192:207], v[32:35], v[16:19], v[192:207]
    v_mfma_f32_32x32x16_bf16 v[192:207], v[128:131], v[96:99], v[192:207]
    v_mfma_f32_32x32x16_bf16 v[192:207], v[132:135], v[100:103], v[192:207]
    v_mfma_f32_32x32x16_bf16 v[192:207], v[36:39], v[20:23], v[192:207]
    s_bitset0_b32 s12, 3
L_o0_3:
    s_xor_b32 s9, s101, 0x9000
    buffer_load_dwordx4 v[148:151], v251, s[64:67], s9 offen offset:0 sc1
    buffer_load_dwordx4 v[44:47], v251, s[64:67], s9 offen offset:1024 sc1
    buffer_load_dwordx4 v[152:155], v251, s[64:67], s9 offen offset:2048 sc1
    buffer_load_dwordx4 v[156:159], v251, s[64:67], s9 offen offset:3072 sc1
    s_waitcnt vmcnt(4)
    v_max3_u32 v249, v136, v137, v138
    v_max3_u32 v249, v139, v140, v249
    v_max3_u32 v249, v141, v142, v249
    v_max3_u32 v249, v143, v40, v249
    v_max3_u32 v249, v41, v42, v249
    v_max3_u32 v249, v43, v144, v249
    v_max3_u32 v249, v145, v146, v249
    v_max_u32 v249, v147, v249
    v_cmp_eq_u32 vcc, -1, v249
    s_nop 0
    s_cbranch_vccnz L_o0_0
    v_mfma_f32_32x32x16_bf16 v[192:207], v[136:139], v[0:3], v[192:207]
    v_mfma_f32_32x32x16_bf16 v[192:207], v[140:143], v[64:67], v[192:207]
    v_mfma_f32_32x32x16_bf16 v[192:207], v[40:43], v[68:71], v[192:207]
    v_mfma_f32_32x32x16_bf16 v[192:207], v[144:147], v[4:7], v[192:207]
    s_bitset0_b32 s12, 0
L_o0_0:
    s_xor_b32 s9, s101, 0xa000
    buffer_load_dwordx4 v[48:51], v251, s[64:67], s9 offen offset:0 sc1
    buffer_load_dwordx4 v[160:163], v251, s[64:67], s9 offen offset:1024 sc1
    buffer_load_dwordx4 v[164:167], v251, s[64:67], s9 offen offset:2048 sc1
    buffer_load_dwordx4 v[52:55], v251, s[64:67], s9 offen offset:3072 sc1
    s_xor_b32 s9, s101, 0xb000
    buffer_load_dwordx4 v[168:171], v251, s[64:67], s9 offen offset:0 sc1
    buffer_load_dwordx4 v[172:175], v251, s[64:67], s9 offen offset:1024 sc1
    buffer_load_dwordx4 v[56:59], v251, s[64:67], s9 offen offset:2048 sc1
    buffer_load_dwordx4 v[176:179], v251, s[64:67], s9 offen offset:3072 sc1
    s_xor_b32 s9, s101, 0x8000
    buffer_load_dwordx4 v[180:183], v251, s[64:67], s9 offen offset:0 sc1
    buffer_load_dwordx4 v[60:63], v251, s[64:67], s9 offen offset:1024 sc1
    buffer_load_dwordx4 v[184:187], v251, s[64:67], s9 offen offset:2048 sc1
    buffer_load_dwordx4 v[188:191], v251, s[64:67], s9 offen offset:3072 sc1
    s_mov_b32 s68, s44
    s_mov_b32 s69, s45
    s_mov_b32 s70, 0x800000
    s_mov_b32 s71, 0x20000
    s_lshr_b32 s10, s72, 1
    s_mov_b32 s15, 50000
    s_lshl_b32 s14, s4, 18
    s_lshl_b32 s9, s5, 1
    s_and_b32 s11, s3, 1
    s_add_u32 s9, s9, s11
    s_lshl_b32 s9, s9, 7
    s_add_u32 s14, s14, s9
    s_lshl_b32 s9, s10, 17
    s_add_u32 s14, s14, s9
    s_waitcnt vmcnt(12)
    v_max3_u32 v249, v148, v149, v150
    v_max3_u32 v249, v151, v44, v249
    v_max3_u32 v249, v45, v46, v249
    v_max3_u32 v249, v47, v152, v249
    v_max3_u32 v249, v153, v154, v249
    v_max3_u32 v249, v155, v156, v249
    v_max3_u32 v249, v157, v158, v249
    v_max_u32 v249, v159, v249
    v_cmp_eq_u32 vcc, -1, v249
    s_nop 0
    s_cbranch_vccnz L_o1_1
    v_mfma_f32_32x32x16_bf16 v[208:223], v[148:151], v[72:75], v[208:223]
    v_mfma_f32_32x32x16_bf16 v[208:223], v[44:47], v[76:79], v[208:223]
    v_mfma_f32_32x32x16_bf16 v[208:223], v[152:155], v[8:11], v[208:223]
    v_mfma_f32_32x32x16_bf16 v[208:223], v[156:159], v[80:83], v[208:223]
    s_bitset0_b32 s12, 5
L_o1_1:
    s_waitcnt vmcnt(8)
    v_max3_u32 v249, v48, v49, v50
    v_max3_u32 v249, v51, v160, v249
    v_max3_u32 v249, v161, v162, v249
    v_max3_u32 v249, v163, v164, v249
    v_max3_u32 v249, v165, v166, v249
    v_max3_u32 v249, v167, v52, v249
    v_max3_u32 v249, v53, v54, v249
    v_max_u32 v249, v55, v249
    v_cmp_eq_u32 vcc, -1, v249
    s_nop 0
    s_cbranch_vccnz L_o1_2
    v_mfma_f32_32x32x16_bf16 v[208:223], v[48:51], v[84:87], v[208:223]
    v_mfma_f32_32x32x16_bf16 v[208:223], v[160:163], v[12:15], v[208:223]
    v_mfma_f32_32x32x16_bf16 v[208:223], v[164:167], v[88:91], v[208:223]
    v_mfma_f32_32x32x16_bf16 v[208:223], v[52:55], v[92:95], v[208:223]
    s_bitset0_b32 s12, 6
L_o1_2:
    s_waitcnt vmcnt(4)
    v_max3_u32 v249, v168, v169, v170
    v_max3_u32 v249, v171, v172, v249
    v_max3_u32 v249, v173, v174, v249
    v_max3_u32 v249, v175, v56, v249
    v_max3_u32 v249, v57, v58, v249
    v_max3_u32 v249, v59, v176, v249
    v_max3_u32 v249, v177, v178, v249
    v_max_u32 v249, v179, v249
    v_cmp_eq_u32 vcc, -1, v249
    s_nop 0
    s_cbranch_vccnz L_o1_3
    v_mfma_f32_32x32x16_bf16 v[208:223], v[168:171], v[16:19], v[208:223]
    v_mfma_f32_32x32x16_bf16 v[208:223], v[172:175], v[96:99], v[208:223]
    v_mfma_f32_32x32x16_bf16 v[208:223], v[56:59], v[100:103], v[208:223]
    v_mfma_f32_32x32x16_bf16 v[208:223], v[176:179], v[20:23], v[208:223]
    s_bitset0_b32 s12, 7
L_o1_3:
    s_waitcnt vmcnt(0)
    v_max3_u32 v249, v180, v181, v182
    v_max3_u32 v249, v183, v60, v249
    v_max3_u32 v249, v61, v62, v249
    v_max3_u32 v249, v63, v184, v249
    v_max3_u32 v249, v185, v186, v249
    v_max3_u32 v249, v187, v188, v249
    v_max3_u32 v249, v189, v190, v249
    v_max_u32 v249, v191, v249
    v_cmp_eq_u32 vcc, -1, v249
    s_nop 0
    s_cbranch_vccnz L_o1_0
    v_mfma_f32_32x32x16_bf16 v[208:223], v[180:183], v[0:3], v[208:223]
    v_mfma_f32_32x32x16_bf16 v[208:223], v[60:63], v[64:67], v[208:223]
    v_mfma_f32_32x32x16_bf16 v[208:223], v[184:187], v[68:71], v[208:223]
    v_mfma_f32_32x32x16_bf16 v[208:223], v[188:191], v[4:7], v[208:223]
    s_bitset0_b32 s12, 4
L_o1_0:
L_oretry:
    s_cmp_eq_u32 s12, 0
    s_cbranch_scc1 L_odone
    s_sub_u32 s15, s15, 1
    s_cbranch_scc1 L_odone
    s_bitcmp0_b32 s12, 0
    s_cbranch_scc1 L_ol_0
    s_xor_b32 s9, s101, 0x0
    buffer_load_dwordx4 v[136:139], v251, s[64:67], s9 offen offset:0 sc1
    buffer_load_dwordx4 v[140:143], v251, s[64:67], s9 offen offset:1024 sc1
    buffer_load_dwordx4 v[40:43], v251, s[64:67], s9 offen offset:2048 sc1
    buffer_load_dwordx4 v[144:147], v251, s[64:67], s9 offen offset:3072 sc1
L_ol_0:
    s_bitcmp0_b32 s12, 1
    s_cbranch_scc1 L_ol_1
    s_xor_b32 s9, s101, 0x1000
    buffer_load_dwordx4 v[104:107], v251, s[64:67], s9 offen offset:0 sc1
    buffer_load_dwordx4 v[108:111], v251, s[64:67], s9 offen offset:1024 sc1
    buffer_load_dwordx4 v[24:27], v251, s[64:67], s9 offen offset:2048 sc1
    buffer_load_dwordx4 v[112:115], v251, s[64:67], s9 offen offset:3072 sc1
L_ol_1:
    s_bitcmp0_b32 s12, 2
    s_cbranch_scc1 L_ol_2
    s_xor_b32 s9, s101, 0x2000
    buffer_load_dwordx4 v[116:119], v251, s[64:67], s9 offen offset:0 sc1
    buffer_load_dwordx4 v[28:31], v251, s[64:67], s9 offen offset:1024 sc1
    buffer_load_dwordx4 v[120:123], v251, s[64:67], s9 offen offset:2048 sc1
    buffer_load_dwordx4 v[124:127], v251, s[64:67], s9 offen offset:3072 sc1
L_ol_2:
    s_bitcmp0_b32 s12, 3
    s_cbranch_scc1 L_ol_3
    s_xor_b32 s9, s101, 0x3000
    buffer_load_dwordx4 v[32:35], v251, s[64:67], s9 offen offset:0 sc1
    buffer_load_dwordx4 v[128:131], v251, s[64:67], s9 offen offset:1024 sc1
    buffer_load_dwordx4 v[132:135], v251, s[64:67], s9 offen offset:2048 sc1
    buffer_load_dwordx4 v[36:39], v251, s[64:67], s9 offen offset:3072 sc1
L_ol_3:
    s_bitcmp0_b32 s12, 4
    s_cbranch_scc1 L_ol_4
    s_xor_b32 s9, s101, 0x8000
    buffer_load_dwordx4 v[180:183], v251, s[64:67], s9 offen offset:0 sc1
    buffer_load_dwordx4 v[60:63], v251, s[64:67], s9 offen offset:1024 sc1
    buffer_load_dwordx4 v[184:187], v251, s[64:67], s9 offen offset:2048 sc1
    buffer_load_dwordx4 v[188:191], v251, s[64:67], s9 offen offset:3072 sc1
L_ol_4:
    s_bitcmp0_b32 s12, 5
    s_cbranch_scc1 L_ol_5
    s_xor_b32 s9, s101, 0x9000
    buffer_load_dwordx4 v[148:151], v251, s[64:67], s9 offen offset:0 sc1
    buffer_load_dwordx4 v[44:47], v251, s[64:67], s9 offen offset:1024 sc1
    buffer_load_dwordx4 v[152:155], v251, s[64:67], s9 offen offset:2048 sc1
    buffer_load_dwordx4 v[156:159], v251, s[64:67], s9 offen offset:3072 sc1
L_ol_5:
    s_bitcmp0_b32 s12, 6
    s_cbranch_scc1 L_ol_6
    s_xor_b32 s9, s101, 0xa000
    buffer_load_dwordx4 v[48:51], v251, s[64:67], s9 offen offset:0 sc1
    buffer_load_dwordx4 v[160:163], v251, s[64:67], s9 offen offset:1024 sc1
    buffer_load_dwordx4 v[164:167], v251, s[64:67], s9 offen offset:2048 sc1
    buffer_load_dwordx4 v[52:55], v251, s[64:67], s9 offen offset:3072 sc1
L_ol_6:
    s_bitcmp0_b32 s12, 7
    s_cbranch_scc1 L_ol_7
    s_xor_b32 s9, s101, 0xb000
    buffer_load_dwordx4 v[168:171], v251, s[64:67], s9 offen offset:0 sc1
    buffer_load_dwordx4 v[172:175], v251, s[64:67], s9 offen offset:1024 sc1
    buffer_load_dwordx4 v[56:59], v251, s[64:67], s9 offen offset:2048 sc1
    buffer_load_dwordx4 v[176:179], v251, s[64:67], s9 offen offset:3072 sc1
L_ol_7:
    s_waitcnt vmcnt(0)
    s_bitcmp0_b32 s12, 0
    s_cbranch_scc1 L_o2_0
    v_max3_u32 v249, v136, v137, v138
    v_max3_u32 v249, v139, v140, v249
    v_max3_u32 v249, v141, v142, v249
    v_max3_u32 v249, v143, v40, v249
    v_max3_u32 v249, v41, v42, v249
    v_max3_u32 v249, v43, v144, v249
    v_max3_u32 v249, v145, v146, v249
    v_max_u32 v249, v147, v249
    v_cmp_eq_u32 vcc, -1, v249
    s_nop 0
    s_cbranch_vccnz L_o2_0
    v_mfma_f32_32x32x16_bf16 v[192:207], v[136:139], v[0:3], v[192:207]
    v_mfma_f32_32x32x16_bf16 v[192:207], v[140:143], v[64:67], v[192:207]
    v_mfma_f32_32x32x16_bf16 v[192:207], v[40:43], v[68:71], v[192:207]
    v_mfma_f32_32x32x16_bf16 v[192:207], v[144:147], v[4:7], v[192:207]
    s_bitset0_b32 s12, 0
L_o2_0:
    s_bitcmp0_b32 s12, 1
    s_cbranch_scc1 L_o2_1
    v_max3_u32 v249, v104, v105, v106
    v_max3_u32 v249, v107, v108, v249
    v_max3_u32 v249, v109, v110, v249
    v_max3_u32 v249, v111, v24, v249
    v_max3_u32 v249, v25, v26, v249
    v_max3_u32 v249, v27, v112, v249
    v_max3_u32 v249, v113, v114, v249
    v_max_u32 v249, v115, v249
    v_cmp_eq_u32 vcc, -1, v249
    s_nop 0
    s_cbranch_vccnz L_o2_1
    v_mfma_f32_32x32x16_bf16 v[192:207], v[104:107], v[72:75], v[192:207]
    v_mfma_f32_32x32x16_bf16 v[192:207], v[108:111], v[76:79], v[192:207]
    v_mfma_f32_32x32x16_bf16 v[192:207], v[24:27], v[8:11], v[192:207]
    v_mfma_f32_32x32x16_bf16 v[192:207], v[112:115], v[80:83], v[192:207]
    s_bitset0_b32 s12, 1
L_o2_1:
    s_bitcmp0_b32 s12, 2
    s_cbranch_scc1 L_o2_2
    v_max3_u32 v249, v116, v117, v118
    v_max3_u32 v249, v119, v28, v249
    v_max3_u32 v249, v29, v30, v249
    v_max3_u32 v249, v31, v120, v249
    v_max3_u32 v249, v121, v122, v249
    v_max3_u32 v249, v123, v124, v249
    v_max3_u32 v249, v125, v126, v249
    v_max_u32 v249, v127, v249
    v_cmp_eq_u32 vcc, -1, v249
    s_nop 0
    s_cbranch_vccnz L_o2_2
    v_mfma_f32_32x32x16_bf16 v[192:207], v[116:119], v[84:87], v[192:207]
    v_mfma_f32_32x32x16_bf16 v[192:207], v[28:31], v[12:15], v[192:207]
    v_mfma_f32_32x32x16_bf16 v[192:207], v[120:123], v[88:91], v[192:207]
    v_mfma_f32_32x32x16_bf16 v[192:207], v[124:127], v[92:95], v[192:207]
    s_bitset0_b32 s12, 2
L_o2_2:
    s_bitcmp0_b32 s12, 3
    s_cbranch_scc1 L_o2_3
    v_max3_u32 v249, v32, v33, v34
    v_max3_u32 v249, v35, v128, v249
    v_max3_u32 v249, v129, v130, v249
    v_max3_u32 v249, v131, v132, v249
    v_max3_u32 v249, v133, v134, v249
    v_max3_u32 v249, v135, v36, v249
    v_max3_u32 v249, v37, v38, v249
    v_max_u32 v249, v39, v249
    v_cmp_eq_u32 vcc, -1, v249
    s_nop 0
    s_cbranch_vccnz L_o2_3
    v_mfma_f32_32x32x16_bf16 v[192:207], v[32:35], v[16:19], v[192:207]
    v_mfma_f32_32x32x16_bf16 v[192:207], v[128:131], v[96:99], v[192:207]
    v_mfma_f32_32x32x16_bf16 v[192:207], v[132:135], v[100:103], v[192:207]
    v_mfma_f32_32x32x16_bf16 v[192:207], v[36:39], v[20:23], v[192:207]
    s_bitset0_b32 s12, 3
L_o2_3:
    s_bitcmp0_b32 s12, 4
    s_cbranch_scc1 L_o2_4
    v_max3_u32 v249, v180, v181, v182
    v_max3_u32 v249, v183, v60, v249
    v_max3_u32 v249, v61, v62, v249
    v_max3_u32 v249, v63, v184, v249
    v_max3_u32 v249, v185, v186, v249
    v_max3_u32 v249, v187, v188, v249
    v_max3_u32 v249, v189, v190, v249
    v_max_u32 v249, v191, v249
    v_cmp_eq_u32 vcc, -1, v249
    s_nop 0
    s_cbranch_vccnz L_o2_4
    v_mfma_f32_32x32x16_bf16 v[208:223], v[180:183], v[0:3], v[208:223]
    v_mfma_f32_32x32x16_bf16 v[208:223], v[60:63], v[64:67], v[208:223]
    v_mfma_f32_32x32x16_bf16 v[208:223], v[184:187], v[68:71], v[208:223]
    v_mfma_f32_32x32x16_bf16 v[208:223], v[188:191], v[4:7], v[208:223]
    s_bitset0_b32 s12, 4
L_o2_4:
    s_bitcmp0_b32 s12, 5
    s_cbranch_scc1 L_o2_5
    v_max3_u32 v249, v148, v149, v150
    v_max3_u32 v249, v151, v44, v249
    v_max3_u32 v249, v45, v46, v249
    v_max3_u32 v249, v47, v152, v249
    v_max3_u32 v249, v153, v154, v249
    v_max3_u32 v249, v155, v156, v249
    v_max3_u32 v249, v157, v158, v249
    v_max_u32 v249, v159, v249
    v_cmp_eq_u32 vcc, -1, v249
    s_nop 0
    s_cbranch_vccnz L_o2_5
    v_mfma_f32_32x32x16_bf16 v[208:223], v[148:151], v[72:75], v[208:223]
    v_mfma_f32_32x32x16_bf16 v[208:223], v[44:47], v[76:79], v[208:223]
    v_mfma_f32_32x32x16_bf16 v[208:223], v[152:155], v[8:11], v[208:223]
    v_mfma_f32_32x32x16_bf16 v[208:223], v[156:159], v[80:83], v[208:223]
    s_bitset0_b32 s12, 5
L_o2_5:
    s_bitcmp0_b32 s12, 6
    s_cbranch_scc1 L_o2_6
    v_max3_u32 v249, v48, v49, v50
    v_max3_u32 v249, v51, v160, v249
    v_max3_u32 v249, v161, v162, v249
    v_max3_u32 v249, v163, v164, v249
    v_max3_u32 v249, v165, v166, v249
    v_max3_u32 v249, v167, v52, v249
    v_max3_u32 v249, v53, v54, v249
    v_max_u32 v249, v55, v249
    v_cmp_eq_u32 vcc, -1, v249
    s_nop 0
    s_cbranch_vccnz L_o2_6
    v_mfma_f32_32x32x16_bf16 v[208:223], v[48:51], v[84:87], v[208:223]
    v_mfma_f32_32x32x16_bf16 v[208:223], v[160:163], v[12:15], v[208:223]
    v_mfma_f32_32x32x16_bf16 v[208:223], v[164:167], v[88:91], v[208:223]
    v_mfma_f32_32x32x16_bf16 v[208:223], v[52:55], v[92:95], v[208:223]
    s_bitset0_b32 s12, 6
L_o2_6:
    s_bitcmp0_b32 s12, 7
    s_cbranch_scc1 L_o2_7
    v_max3_u32 v249, v168, v169, v170
    v_max3_u32 v249, v171, v172, v249
    v_max3_u32 v249, v173, v174, v249
    v_max3_u32 v249, v175, v56, v249
    v_max3_u32 v249, v57, v58, v249
    v_max3_u32 v249, v59, v176, v249
    v_max3_u32 v249, v177, v178, v249
    v_max_u32 v249, v179, v249
    v_cmp_eq_u32 vcc, -1, v249
    s_nop 0
    s_cbranch_vccnz L_o2_7
    v_mfma_f32_32x32x16_bf16 v[208:223], v[168:171], v[16:19], v[208:223]
    v_mfma_f32_32x32x16_bf16 v[208:223], v[172:175], v[96:99], v[208:223]
    v_mfma_f32_32x32x16_bf16 v[208:223], v[56:59], v[100:103], v[208:223]
    v_mfma_f32_32x32x16_bf16 v[208:223], v[176:179], v[20:23], v[208:223]
    s_bitset0_b32 s12, 7
L_o2_7:
    s_branch L_oretry
L_odone:
    s_nop 7
    s_cmp_eq_u32 s10, 0
    s_cbranch_scc0 L_ohi
    ds_write_b128 v242, v[208:211] offset:13312
    ds_write_b128 v242, v[212:215] offset:14336
    ds_write_b128 v242, v[216:219] offset:21504
    ds_write_b128 v242, v[220:223] offset:22528
    ds_write_b32 v254, v255 offset:320
    s_mov_b32 s15, 400000
W_41:
    ds_read_b32 v249, v246 offset:320
    s_waitcnt lgkmcnt(0)
    v_cmp_eq_u32 vcc, 0, v249
    s_nop 0
    s_cbranch_vccz WD_42
    s_sub_u32 s15, s15, 1
    s_cbranch_scc0 W_41
WD_42:
    ds_read_b128 v[0:3], v245 offset:13312
    ds_read_b128 v[4:7], v245 offset:14336
    ds_read_b128 v[8:11], v245 offset:21504
    ds_read_b128 v[12:15], v245 offset:22528
    s_waitcnt lgkmcnt(3)
    v_add_f32 v0, v0, v192
    s_add_u32 s9, s14, 0
    buffer_store_dword v0, v243, s[68:71], s9 offen nt
    v_add_f32 v1, v1, v193
    s_add_u32 s9, s14, 4096
    buffer_store_dword v1, v243, s[68:71], s9 offen nt
    v_add_f32 v2, v2, v194
    s_add_u32 s9, s14, 8192
    buffer_store_dword v2, v243, s[68:71], s9 offen nt
    v_add_f32 v3, v3, v195
    s_add_u32 s9, s14, 12288
    buffer_store_dword v3, v243, s[68:71], s9 offen nt
    s_waitcnt lgkmcnt(2)
    v_add_f32 v4, v4, v196
    s_add_u32 s9, s14, 32768
    buffer_store_dword v4, v243, s[68:71], s9 offen nt
    v_add_f32 v5, v5, v197
    s_add_u32 s9, s14, 36864
    buffer_store_dword v5, v243, s[68:71], s9 offen nt
    v_add_f32 v6, v6, v198
    s_add_u32 s9, s14, 40960
    buffer_store_dword v6, v243, s[68:71], s9 offen nt
    v_add_f32 v7, v7, v199
    s_add_u32 s9, s14, 45056
    buffer_store_dword v7, v243, s[68:71], s9 offen nt
    s_waitcnt lgkmcnt(1)
    v_add_f32 v8, v8, v200
    s_add_u32 s9, s14, 65536
    buffer_store_dword v8, v243, s[68:71], s9 offen nt
    v_add_f32 v9, v9, v201
    s_add_u32 s9, s14, 69632
    buffer_store_dword v9, v243, s[68:71], s9 offen nt
    v_add_f32 v10, v10, v202
    s_add_u32 s9, s14, 73728
    buffer_store_dword v10, v243, s[68:71], s9 offen nt
    v_add_f32 v11, v11, v203
    s_add_u32 s9, s14, 77824
    buffer_store_dword v11, v243, s[68:71], s9 offen nt
    s_waitcnt lgkmcnt(0)
    v_add_f32 v12, v12, v204
    s_add_u32 s9, s14, 98304
    buffer_store_dword v12, v243, s[68:71], s9 offen nt
    v_add_f32 v13, v13, v205
    s_add_u32 s9, s14, 102400
    buffer_store_dword v13, v243, s[68:71], s9 offen nt
    v_add_f32 v14, v14, v206
    s_add_u32 s9, s14, 106496
    buffer_store_dword v14, v243, s[68:71], s9 offen nt
    v_add_f32 v15, v15, v207
    s_add_u32 s9, s14, 110592
    buffer_store_dword v15, v243, s[68:71], s9 offen nt
    s_endpgm
L_ohi:
    ds_write_b128 v242, v[192:195] offset:13312
    ds_write_b128 v242, v[196:199] offset:14336
    ds_write_b128 v242, v[200:203] offset:21504
    ds_write_b128 v242, v[204:207] offset:22528
    ds_write_b32 v254, v255 offset:320
    s_mov_b32 s15, 400000
W_43:
    ds_read_b32 v249, v246 offset:320
    s_waitcnt lgkmcnt(0)
    v_cmp_eq_u32 vcc, 0, v249
    s_nop 0
    s_cbranch_vccz WD_44
    s_sub_u32 s15, s15, 1
    s_cbranch_scc0 W_43
WD_44:
    ds_read_b128 v[0:3], v245 offset:13312
    ds_read_b128 v[4:7], v245 offset:14336
    ds_read_b128 v[8:11], v245 offset:21504
    ds_read_b128 v[12:15], v245 offset:22528
    s_waitcnt lgkmcnt(3)
    v_add_f32 v0, v0, v208
    s_add_u32 s9, s14, 0
    buffer_store_dword v0, v243, s[68:71], s9 offen nt
    v_add_f32 v1, v1, v209
    s_add_u32 s9, s14, 4096
    buffer_store_dword v1, v243, s[68:71], s9 offen nt
    v_add_f32 v2, v2, v210
    s_add_u32 s9, s14, 8192
    buffer_store_dword v2, v243, s[68:71], s9 offen nt
    v_add_f32 v3, v3, v211
    s_add_u32 s9, s14, 12288
    buffer_store_dword v3, v243, s[68:71], s9 offen nt
    s_waitcnt lgkmcnt(2)
    v_add_f32 v4, v4, v212
    s_add_u32 s9, s14, 32768
    buffer_store_dword v4, v243, s[68:71], s9 offen nt
    v_add_f32 v5, v5, v213
    s_add_u32 s9, s14, 36864
    buffer_store_dword v5, v243, s[68:71], s9 offen nt
    v_add_f32 v6, v6, v214
    s_add_u32 s9, s14, 40960
    buffer_store_dword v6, v243, s[68:71], s9 offen nt
    v_add_f32 v7, v7, v215
    s_add_u32 s9, s14, 45056
    buffer_store_dword v7, v243, s[68:71], s9 offen nt
    s_waitcnt lgkmcnt(1)
    v_add_f32 v8, v8, v216
    s_add_u32 s9, s14, 65536
    buffer_store_dword v8, v243, s[68:71], s9 offen nt
    v_add_f32 v9, v9, v217
    s_add_u32 s9, s14, 69632
    buffer_store_dword v9, v243, s[68:71], s9 offen nt
    v_add_f32 v10, v10, v218
    s_add_u32 s9, s14, 73728
    buffer_store_dword v10, v243, s[68:71], s9 offen nt
    v_add_f32 v11, v11, v219
    s_add_u32 s9, s14, 77824
    buffer_store_dword v11, v243, s[68:71], s9 offen nt
    s_waitcnt lgkmcnt(0)
    v_add_f32 v12, v12, v220
    s_add_u32 s9, s14, 98304
    buffer_store_dword v12, v243, s[68:71], s9 offen nt
    v_add_f32 v13, v13, v221
    s_add_u32 s9, s14, 102400
    buffer_store_dword v13, v243, s[68:71], s9 offen nt
    v_add_f32 v14, v14, v222
    s_add_u32 s9, s14, 106496
    buffer_store_dword v14, v243, s[68:71], s9 offen nt
    v_add_f32 v15, v15, v223
    s_add_u32 s9, s14, 110592
    buffer_store_dword v15, v243, s[68:71], s9 offen nt
    s_endpgm
L_check6:
    s_mov_b32 s15, 400000
W_45:
    ds_read_b32 v249, v253 offset:288
    s_waitcnt lgkmcnt(0)
    v_cmp_eq_u32 vcc, 0, v249
    s_nop 0
    s_cbranch_vccz WD_46
    s_sleep 1
    s_sub_u32 s15, s15, 1
    s_cbranch_scc0 W_45
WD_46:
    s_branch L_checked6
L_check1:
    s_mov_b32 s15, 400000
W_47:
    ds_read_b32 v249, v253 offset:144
    s_waitcnt lgkmcnt(0)
    v_cmp_eq_u32 vcc, 0, v249
    s_nop 0
    s_cbranch_vccz WD_48
    s_sleep 1
    s_sub_u32 s15, s15, 1
    s_cbranch_scc0 W_47
WD_48:
    v_cmp_ne_u32 vcc, 1, v249
    s_nop 0
    s_cbranch_vccz L_checked1
    s_mov_b32 s15, 400000
W_49:
    ds_read_b32 v249, v253 offset:288
    s_waitcnt lgkmcnt(0)
    v_cmp_eq_u32 vcc, 0, v249
    s_nop 0
    s_cbranch_vccz WD_50
    s_sleep 1
    s_sub_u32 s15, s15, 1
    s_cbranch_scc0 W_49
WD_50:
    ds_write_b32 v254, v255 offset:352
    s_mov_b32 s15, 400000
W_51:
    ds_read_b32 v249, v253 offset:352
    s_waitcnt lgkmcnt(0)
    v_cmp_eq_u32 vcc, 0, v249
    s_nop 0
    s_cbranch_vccz WD_52
    s_sleep 1
    s_sub_u32 s15, s15, 1
    s_cbranch_scc0 W_51
WD_52:
    v_lshrrev_b32 v246, 2, v251
    s_mov_b32 s11, 0
    s_lshl_b32 s12, s3, 11
    v_add_u32 v245, s12, v246
L_slow_pre:
    s_lshl_b32 s9, s11, 10
    v_add_u32 v249, s9, v251
    ds_read_b128 v[240:243], v249 offset:5120
    s_waitcnt lgkmcnt(0)
    v_mov_b32 v212, 0xff800000
    v_mfma_f32_32x32x16_bf16 v[192:207], v[0:3], v[240:243], 0
    s_nop 11
    v_max3_f32 v212, v192, v193, v212
    v_max3_f32 v212, v194, v195, v212
    v_max3_f32 v212, v196, v197, v212
    v_max3_f32 v212, v198, v199, v212
    v_max3_f32 v212, v200, v201, v212
    v_max3_f32 v212, v202, v203, v212
    v_max3_f32 v212, v204, v205, v212
    v_max3_f32 v212, v206, v207, v212
    v_mfma_f32_32x32x16_bf16 v[192:207], v[4:7], v[240:243], 0
    s_nop 11
    v_max3_f32 v212, v192, v193, v212
    v_max3_f32 v212, v194, v195, v212
    v_max3_f32 v212, v196, v197, v212
    v_max3_f32 v212, v198, v199, v212
    v_max3_f32 v212, v200, v201, v212
    v_max3_f32 v212, v202, v203, v212
    v_max3_f32 v212, v204, v205, v212
    v_max3_f32 v212, v206, v207, v212
    v_mfma_f32_32x32x16_bf16 v[192:207], v[8:11], v[240:243], 0
    s_nop 11
    v_max3_f32 v212, v192, v193, v212
    v_max3_f32 v212, v194, v195, v212
    v_max3_f32 v212, v196, v197, v212
    v_max3_f32 v212, v198, v199, v212
    v_max3_f32 v212, v200, v201, v212
    v_max3_f32 v212, v202, v203, v212
    v_max3_f32 v212, v204, v205, v212
    v_max3_f32 v212, v206, v207, v212
    v_mfma_f32_32x32x16_bf16 v[192:207], v[12:15], v[240:243], 0
    s_nop 11
    v_max3_f32 v212, v192, v193, v212
    v_max3_f32 v212, v194, v195, v212
    v_max3_f32 v212, v196, v197, v212
    v_max3_f32 v212, v198, v199, v212
    v_max3_f32 v212, v200, v201, v212
    v_max3_f32 v212, v202, v203, v212
    v_max3_f32 v212, v204, v205, v212
    v_max3_f32 v212, v206, v207, v212
    v_mfma_f32_32x32x16_bf16 v[192:207], v[16:19], v[240:243], 0
    s_nop 11
    v_max3_f32 v212, v192, v193, v212
    v_max3_f32 v212, v194, v195, v212
    v_max3_f32 v212, v196, v197, v212
    v_max3_f32 v212, v198, v199, v212
    v_max3_f32 v212, v200, v201, v212
    v_max3_f32 v212, v202, v203, v212
    v_max3_f32 v212, v204, v205, v212
    v_max3_f32 v212, v206, v207, v212
    v_mfma_f32_32x32x16_bf16 v[192:207], v[20:23], v[240:243], 0
    s_nop 11
    v_max3_f32 v212, v192, v193, v212
    v_max3_f32 v212, v194, v195, v212
    v_max3_f32 v212, v196, v197, v212
    v_max3_f32 v212, v198, v199, v212
    v_max3_f32 v212, v200, v201, v212
    v_max3_f32 v212, v202, v203, v212
    v_max3_f32 v212, v204, v205, v212
    v_max3_f32 v212, v206, v207, v212
    v_mfma_f32_32x32x16_bf16 v[192:207], v[24:27], v[240:243], 0
    s_nop 11
    v_max3_f32 v212, v192, v193, v212
    v_max3_f32 v212, v194, v195, v212
    v_max3_f32 v212, v196, v197, v212
    v_max3_f32 v212, v198, v199, v212
    v_max3_f32 v212, v200, v201, v212
    v_max3_f32 v212, v202, v203, v212
    v_max3_f32 v212, v204, v205, v212
    v_max3_f32 v212, v206, v207, v212
    v_mfma_f32_32x32x16_bf16 v[192:207], v[28:31], v[240:243], 0
    s_nop 11
    v_max3_f32 v212, v192, v193, v212
    v_max3_f32 v212, v194, v195, v212
    v_max3_f32 v212, v196, v197, v212
    v_max3_f32 v212, v198, v199, v212
    v_max3_f32 v212, v200, v201, v212
    v_max3_f32 v212, v202, v203, v212
    v_max3_f32 v212, v204, v205, v212
    v_max3_f32 v212, v206, v207, v212
    v_mfma_f32_32x32x16_bf16 v[192:207], v[32:35], v[240:243], 0
    s_nop 11
    v_max3_f32 v212, v192, v193, v212
    v_max3_f32 v212, v194, v195, v212
    v_max3_f32 v212, v196, v197, v212
    v_max3_f32 v212, v198, v199, v212
    v_max3_f32 v212, v200, v201, v212
    v_max3_f32 v212, v202, v203, v212
    v_max3_f32 v212, v204, v205, v212
    v_max3_f32 v212, v206, v207, v212
    v_mfma_f32_32x32x16_bf16 v[192:207], v[36:39], v[240:243], 0
    s_nop 11
    v_max3_f32 v212, v192, v193, v212
    v_max3_f32 v212, v194, v195, v212
    v_max3_f32 v212, v196, v197, v212
    v_max3_f32 v212, v198, v199, v212
    v_max3_f32 v212, v200, v201, v212
    v_max3_f32 v212, v202, v203, v212
    v_max3_f32 v212, v204, v205, v212
    v_max3_f32 v212, v206, v207, v212
    v_mfma_f32_32x32x16_bf16 v[192:207], v[40:43], v[240:243], 0
    s_nop 11
    v_max3_f32 v212, v192, v193, v212
    v_max3_f32 v212, v194, v195, v212
    v_max3_f32 v212, v196, v197, v212
    v_max3_f32 v212, v198, v199, v212
    v_max3_f32 v212, v200, v201, v212
    v_max3_f32 v212, v202, v203, v212
    v_max3_f32 v212, v204, v205, v212
    v_max3_f32 v212, v206, v207, v212
    v_mfma_f32_32x32x16_bf16 v[192:207], v[44:47], v[240:243], 0
    s_nop 11
    v_max3_f32 v212, v192, v193, v212
    v_max3_f32 v212, v194, v195, v212
    v_max3_f32 v212, v196, v197, v212
    v_max3_f32 v212, v198, v199, v212
    v_max3_f32 v212, v200, v201, v212
    v_max3_f32 v212, v202, v203, v212
    v_max3_f32 v212, v204, v205, v212
    v_max3_f32 v212, v206, v207, v212
    v_mfma_f32_32x32x16_bf16 v[192:207], v[48:51], v[240:243], 0
    s_nop 11
    v_max3_f32 v212, v192, v193, v212
    v_max3_f32 v212, v194, v195, v212
    v_max3_f32 v212, v196, v197, v212
    v_max3_f32 v212, v198, v199, v212
    v_max3_f32 v212, v200, v201, v212
    v_max3_f32 v212, v202, v203, v212
    v_max3_f32 v212, v204, v205, v212
    v_max3_f32 v212, v206, v207, v212
    v_mfma_f32_32x32x16_bf16 v[192:207], v[52:55], v[240:243], 0
    s_nop 11
    v_max3_f32 v212, v192, v193, v212
    v_max3_f32 v212, v194, v195, v212
    v_max3_f32 v212, v196, v197, v212
    v_max3_f32 v212, v198, v199, v212
    v_max3_f32 v212, v200, v201, v212
    v_max3_f32 v212, v202, v203, v212
    v_max3_f32 v212, v204, v205, v212
    v_max3_f32 v212, v206, v207, v212
    v_mfma_f32_32x32x16_bf16 v[192:207], v[56:59], v[240:243], 0
    s_nop 11
    v_max3_f32 v212, v192, v193, v212
    v_max3_f32 v212, v194, v195, v212
    v_max3_f32 v212, v196, v197, v212
    v_max3_f32 v212, v198, v199, v212
    v_max3_f32 v212, v200, v201, v212
    v_max3_f32 v212, v202, v203, v212
    v_max3_f32 v212, v204, v205, v212
    v_max3_f32 v212, v206, v207, v212
    v_mfma_f32_32x32x16_bf16 v[192:207], v[60:63], v[240:243], 0
    s_nop 11
    v_max3_f32 v212, v192, v193, v212
    v_max3_f32 v212, v194, v195, v212
    v_max3_f32 v212, v196, v197, v212
    v_max3_f32 v212, v198, v199, v212
    v_max3_f32 v212, v200, v201, v212
    v_max3_f32 v212, v202, v203, v212
    v_max3_f32 v212, v204, v205, v212
    v_max3_f32 v212, v206, v207, v212
    v_mov_b32 v213, v212
    s_nop 1
    v_permlane32_swap_b32 v212, v213
    v_max_f32 v212, v212, v213
    ds_write_b32 v245, v212 offset:13312
    v_add_u32 v245, 256, v245
    s_add_u32 s11, s11, 1
    s_cmp_lt_u32 s11, 8
    s_cbranch_scc1 L_slow_pre
    ds_write_b32 v254, v255 offset:368
    s_mov_b32 s15, 400000
W_53:
    ds_read_b32 v249, v253 offset:368
    s_waitcnt lgkmcnt(0)
    v_cmp_eq_u32 vcc, 0, v249
    s_nop 0
    s_cbranch_vccz WD_54
    s_sleep 1
    s_sub_u32 s15, s15, 1
    s_cbranch_scc0 W_53
WD_54:
    s_lshl_b32 s9, s3, 8
    v_add_u32 v245, s9, v246
    ds_read_b32 v192, v245 offset:13312
    ds_read_b32 v193, v245 offset:15360
    ds_read_b32 v194, v245 offset:17408
    ds_read_b32 v195, v245 offset:19456
    ds_read_b32 v196, v245 offset:14336
    ds_read_b32 v197, v245 offset:16384
    ds_read_b32 v198, v245 offset:18432
    ds_read_b32 v199, v245 offset:20480
    v_and_b32 v245, 0x7c, v246
    s_lshl_b32 s9, s3, 7
    s_add_u32 s9, s9, 162816
    v_add_u32 v245, s9, v245
    s_waitcnt lgkmcnt(0)
    v_max3_f32 v192, v192, v193, v194
    v_max_f32 v192, v192, v195
    ds_write_b32 v245, v192 offset:0
    v_max3_f32 v196, v196, v197, v198
    v_max_f32 v196, v196, v199
    ds_write_b32 v245, v196 offset:512
    v_mov_b32 v224, 0
    v_mov_b32 v225, 0
    v_mov_b32 v226, 0
    v_mov_b32 v227, 0
    v_mov_b32 v228, 0
    v_mov_b32 v229, 0
    v_mov_b32 v230, 0
    v_mov_b32 v231, 0
    v_mov_b32 v232, 0
    v_mov_b32 v233, 0
    v_mov_b32 v234, 0
    v_mov_b32 v235, 0
    v_mov_b32 v236, 0
    v_mov_b32 v237, 0
    v_mov_b32 v238, 0
    v_mov_b32 v239, 0
    s_mov_b32 s74, s72
    s_mov_b32 s73, 16
    s_lshl_b32 s9, s74, 10
    v_add_u32 v247, s9, v251
    s_lshl_b32 s9, s74, 11
    v_add_u32 v245, s9, v251
    s_lshl_b32 s9, s74, 9
    v_add_u32 v246, s9, v248
    v_mov_b32 v192, 0
    v_mov_b32 v193, 17
    ds_write_b64 v246, v[192:193] offset:3072
    ds_write_b128 v245, v[224:227] offset:21504
    ds_write_b128 v245, v[224:227] offset:22528
    ds_write_b32 v254, v255 offset:384
    s_mov_b32 s15, 400000
W_55:
    ds_read_b32 v249, v253 offset:384
    s_waitcnt lgkmcnt(0)
    v_cmp_eq_u32 vcc, 0, v249
    s_nop 0
    s_cbranch_vccz WD_56
    s_sleep 1
    s_sub_u32 s15, s15, 1
    s_cbranch_scc0 W_55
WD_56:
    ds_read_b128 v[240:243], v247 offset:5120
    s_setprio 1
    v_lshrrev_b32 v249, 2, v251
    v_and_b32 v249, 0x7c, v249
    s_lshl_b32 s9, s74, 7
    s_add_u32 s9, s9, 162816
    v_add_u32 v249, s9, v249
    ds_read_b32 v252, v249
    s_waitcnt lgkmcnt(0)
    s_waitcnt vmcnt(11) lgkmcnt(0)
    v_mfma_f32_32x32x16_bf16 v[192:207], v[0:3], v[240:243], 0
    s_nop 11
    v_sub_f32 v192, v192, v252
    v_exp_f32 v192, v192
    v_sub_f32 v193, v193, v252
    v_exp_f32 v193, v193
    v_sub_f32 v194, v194, v252
    v_exp_f32 v194, v194
    v_sub_f32 v195, v195, v252
    v_exp_f32 v195, v195
    v_sub_f32 v196, v196, v252
    v_exp_f32 v196, v196
    v_mfma_f32_32x32x16_bf16 v[208:223], v[4:7], v[240:243], 0
    v_sub_f32 v197, v197, v252
    v_exp_f32 v197, v197
    v_sub_f32 v198, v198, v252
    v_exp_f32 v198, v198
    v_sub_f32 v199, v199, v252
    v_exp_f32 v199, v199
    v_sub_f32 v200, v200, v252
    v_exp_f32 v200, v200
    v_sub_f32 v201, v201, v252
    v_exp_f32 v201, v201
    v_sub_f32 v202, v202, v252
    v_exp_f32 v202, v202
    v_smfmac_f32_32x32x32_bf16 v[224:239], v[64:67], v[192:199], v244
    v_sub_f32 v203, v203, v252
    v_exp_f32 v203, v203
    v_sub_f32 v204, v204, v252
    v_exp_f32 v204, v204
    v_sub_f32 v205, v205, v252
    v_exp_f32 v205, v205
    v_sub_f32 v206, v206, v252
    v_exp_f32 v206, v206
    v_sub_f32 v207, v207, v252
    v_exp_f32 v207, v207
    v_sub_f32 v208, v208, v252
    v_exp_f32 v208, v208
    v_sub_f32 v209, v209, v252
    v_exp_f32 v209, v209
    v_smfmac_f32_32x32x32_bf16 v[224:239], v[68:71], v[200:207], v244
    v_sub_f32 v210, v210, v252
    v_exp_f32 v210, v210
    v_sub_f32 v211, v211, v252
    v_exp_f32 v211, v211
    v_sub_f32 v212, v212, v252
    v_exp_f32 v212, v212
    v_mfma_f32_32x32x16_bf16 v[192:207], v[8:11], v[240:243], 0
    v_sub_f32 v213, v213, v252
    v_exp_f32 v213, v213
    v_sub_f32 v214, v214, v252
    v_exp_f32 v214, v214
    v_sub_f32 v215, v215, v252
    v_exp_f32 v215, v215
    v_sub_f32 v216, v216, v252
    v_exp_f32 v216, v216
    v_sub_f32 v217, v217, v252
    v_exp_f32 v217, v217
    v_sub_f32 v218, v218, v252
    v_exp_f32 v218, v218
    v_smfmac_f32_32x32x32_bf16 v[224:239], v[72:75], v[208:215], v244
    v_sub_f32 v219, v219, v252
    v_exp_f32 v219, v219
    v_sub_f32 v220, v220, v252
    v_exp_f32 v220, v220
    v_sub_f32 v221, v221, v252
    v_exp_f32 v221, v221
    v_sub_f32 v222, v222, v252
    v_exp_f32 v222, v222
    v_sub_f32 v223, v223, v252
    v_exp_f32 v223, v223
    s_branch L_mid_s
.p2align 6
L_loop_s:
    s_add_u32 s73, s73, 1
    s_mov_b32 s74, s11
    v_lshrrev_b32 v249, 2, v251
    v_and_b32 v249, 0x7c, v249
    s_lshl_b32 s9, s74, 7
    s_add_u32 s9, s9, 162816
    v_add_u32 v249, s9, v249
    ds_read_b32 v252, v249
    s_waitcnt lgkmcnt(0)
    v_sub_f32 v192, v192, v252
    v_exp_f32 v192, v192
    v_sub_f32 v193, v193, v252
    v_exp_f32 v193, v193
    v_smfmac_f32_32x32x32_bf16 v[224:239], v[188:191], v[216:223], v244
    v_sub_f32 v194, v194, v252
    v_exp_f32 v194, v194
    s_add_u32 s10, s73, 1
    v_sub_f32 v195, v195, v252
    v_exp_f32 v195, v195
    s_lshl_b32 s12, s74, 9
    v_sub_f32 v196, v196, v252
    v_exp_f32 v196, v196
    v_mfma_f32_32x32x16_bf16 v[208:223], v[4:7], v[240:243], 0
    s_lshl_b32 s13, s74, 11
    v_sub_f32 v197, v197, v252
    v_exp_f32 v197, v197
    v_sub_f32 v198, v198, v252
    v_exp_f32 v198, v198
    s_cmp_eq_u32 s73, 23
    v_sub_f32 v199, v199, v252
    v_exp_f32 v199, v199
    s_cbranch_scc1 L_finx_s
    ds_write_b128 v245, v[224:227] offset:13312
    v_mov_b32 v233, s10
    v_sub_f32 v200, v200, v252
    v_exp_f32 v200, v200
    ds_write_b128 v245, v[228:231] offset:14336
    v_sub_f32 v201, v201, v252
    v_exp_f32 v201, v201
    ds_write_b64 v246, v[232:233] offset:1024
L_finxd_s:
    v_add_u32 v246, s12, v248
    v_add_u32 v245, s13, v251
    ds_read_b64 v[232:233], v246 offset:1024
    v_sub_f32 v202, v202, v252
    v_exp_f32 v202, v202
    ds_read_b128 v[224:227], v245 offset:13312
    v_sub_f32 v203, v203, v252
    v_exp_f32 v203, v203
    ds_read_b128 v[228:231], v245 offset:14336
    v_sub_f32 v204, v204, v252
    v_exp_f32 v204, v204
    v_sub_f32 v205, v205, v252
    v_exp_f32 v205, v205
    v_sub_f32 v206, v206, v252
    v_exp_f32 v206, v206
    v_sub_f32 v207, v207, v252
    v_exp_f32 v207, v207
    v_sub_f32 v208, v208, v252
    v_exp_f32 v208, v208
    v_sub_f32 v209, v209, v252
    v_exp_f32 v209, v209
    v_sub_f32 v210, v210, v252
    v_exp_f32 v210, v210
    v_sub_f32 v211, v211, v252
    v_exp_f32 v211, v211
    v_sub_f32 v212, v212, v252
    v_exp_f32 v212, v212
    v_sub_f32 v213, v213, v252
    v_exp_f32 v213, v213
    s_waitcnt lgkmcnt(0)
    v_cmp_gt_u32 vcc, s73, v233
    s_nop 0
    s_cbranch_vccnz L_hw_s
L_hd_s:
    v_smfmac_f32_32x32x32_bf16 v[224:239], v[64:67], v[192:199], v244
    v_sub_f32 v214, v214, v252
    v_exp_f32 v214, v214
    v_sub_f32 v215, v215, v252
    v_exp_f32 v215, v215
    v_sub_f32 v216, v216, v252
    v_exp_f32 v216, v216
    v_smfmac_f32_32x32x32_bf16 v[224:239], v[68:71], v[200:207], v244
    v_sub_f32 v217, v217, v252
    v_exp_f32 v217, v217
    v_sub_f32 v218, v218, v252
    v_exp_f32 v218, v218
    v_sub_f32 v219, v219, v252
    v_exp_f32 v219, v219
    v_mfma_f32_32x32x16_bf16 v[192:207], v[8:11], v[240:243], 0
    v_sub_f32 v220, v220, v252
    v_exp_f32 v220, v220
    v_sub_f32 v221, v221, v252
    v_exp_f32 v221, v221
    v_sub_f32 v222, v222, v252
    v_exp_f32 v222, v222
    v_smfmac_f32_32x32x32_bf16 v[224:239], v[72:75], v[208:215], v244
    v_sub_f32 v223, v223, v252
    v_exp_f32 v223, v223
L_mid_s:
    v_sub_f32 v192, v192, v252
    v_exp_f32 v192, v192
    v_sub_f32 v193, v193, v252
    v_exp_f32 v193, v193
    v_smfmac_f32_32x32x32_bf16 v[224:239], v[76:79], v[216:223], v244
    v_sub_f32 v194, v194, v252
    v_exp_f32 v194, v194
    v_sub_f32 v195, v195, v252
    v_exp_f32 v195, v195
    v_sub_f32 v196, v196, v252
    v_exp_f32 v196, v196
    v_mfma_f32_32x32x16_bf16 v[208:223], v[12:15], v[240:243], 0
    v_sub_f32 v197, v197, v252
    v_exp_f32 v197, v197
    v_sub_f32 v198, v198, v252
    v_exp_f32 v198, v198
    v_sub_f32 v199, v199, v252
    v_exp_f32 v199, v199
    v_sub_f32 v200, v200, v252
    v_exp_f32 v200, v200
    v_sub_f32 v201, v201, v252
    v_exp_f32 v201, v201
    v_sub_f32 v202, v202, v252
    v_exp_f32 v202, v202
    v_smfmac_f32_32x32x32_bf16 v[224:239], v[80:83], v[192:199], v244
    v_sub_f32 v203, v203, v252
    v_exp_f32 v203, v203
    v_sub_f32 v204, v204, v252
    v_exp_f32 v204, v204
    v_sub_f32 v205, v205, v252
    v_exp_f32 v205, v205
    v_sub_f32 v206, v206, v252
    v_exp_f32 v206, v206
    v_sub_f32 v207, v207, v252
    v_exp_f32 v207, v207
    v_sub_f32 v208, v208, v252
    v_exp_f32 v208, v208
    v_sub_f32 v209, v209, v252
    v_exp_f32 v209, v209
    v_smfmac_f32_32x32x32_bf16 v[224:239], v[84:87], v[200:207], v244
    v_sub_f32 v210, v210, v252
    v_exp_f32 v210, v210
    v_sub_f32 v211, v211, v252
    v_exp_f32 v211, v211
    v_sub_f32 v212, v212, v252
    v_exp_f32 v212, v212
    v_mfma_f32_32x32x16_bf16 v[192:207], v[16:19], v[240:243], 0
    v_sub_f32 v213, v213, v252
    v_exp_f32 v213, v213
    v_sub_f32 v214, v214, v252
    v_exp_f32 v214, v214
    v_sub_f32 v215, v215, v252
    v_exp_f32 v215, v215
    v_sub_f32 v216, v216, v252
    v_exp_f32 v216, v216
    v_sub_f32 v217, v217, v252
    v_exp_f32 v217, v217
    v_sub_f32 v218, v218, v252
    v_exp_f32 v218, v218
    v_smfmac_f32_32x32x32_bf16 v[224:239], v[88:91], v[208:215], v244
    v_sub_f32 v219, v219, v252
    v_exp_f32 v219, v219
    v_sub_f32 v220, v220, v252
    v_exp_f32 v220, v220
    v_sub_f32 v221, v221, v252
    v_exp_f32 v221, v221
    v_sub_f32 v222, v222, v252
    v_exp_f32 v222, v222
    v_sub_f32 v223, v223, v252
    v_exp_f32 v223, v223
    v_sub_f32 v192, v192, v252
    v_exp_f32 v192, v192
    v_sub_f32 v193, v193, v252
    v_exp_f32 v193, v193
    v_smfmac_f32_32x32x32_bf16 v[224:239], v[92:95], v[216:223], v244
    v_sub_f32 v194, v194, v252
    v_exp_f32 v194, v194
    v_sub_f32 v195, v195, v252
    v_exp_f32 v195, v195
    v_sub_f32 v196, v196, v252
    v_exp_f32 v196, v196
    v_mfma_f32_32x32x16_bf16 v[208:223], v[20:23], v[240:243], 0
    v_sub_f32 v197, v197, v252
    v_exp_f32 v197, v197
    v_sub_f32 v198, v198, v252
    v_exp_f32 v198, v198
    v_sub_f32 v199, v199, v252
    v_exp_f32 v199, v199
    v_sub_f32 v200, v200, v252
    v_exp_f32 v200, v200
    v_sub_f32 v201, v201, v252
    v_exp_f32 v201, v201
    v_sub_f32 v202, v202, v252
    v_exp_f32 v202, v202
    v_smfmac_f32_32x32x32_bf16 v[224:239], v[96:99], v[192:199], v244
    v_sub_f32 v203, v203, v252
    v_exp_f32 v203, v203
    v_sub_f32 v204, v204, v252
    v_exp_f32 v204, v204
    v_sub_f32 v205, v205, v252
    v_exp_f32 v205, v205
    v_sub_f32 v206, v206, v252
    v_exp_f32 v206, v206
    v_sub_f32 v207, v207, v252
    v_exp_f32 v207, v207
    v_sub_f32 v208, v208, v252
    v_exp_f32 v208, v208
    v_sub_f32 v209, v209, v252
    v_exp_f32 v209, v209
    v_smfmac_f32_32x32x32_bf16 v[224:239], v[100:103], v[200:207], v244
    v_sub_f32 v210, v210, v252
    v_exp_f32 v210, v210
    v_sub_f32 v211, v211, v252
    v_exp_f32 v211, v211
    v_sub_f32 v212, v212, v252
    v_exp_f32 v212, v212
    v_mfma_f32_32x32x16_bf16 v[192:207], v[24:27], v[240:243], 0
    v_sub_f32 v213, v213, v252
    v_exp_f32 v213, v213
    v_sub_f32 v214, v214, v252
    v_exp_f32 v214, v214
    v_sub_f32 v215, v215, v252
    v_exp_f32 v215, v215
    v_sub_f32 v216, v216, v252
    v_exp_f32 v216, v216
    v_sub_f32 v217, v217, v252
    v_exp_f32 v217, v217
    v_sub_f32 v218, v218, v252
    v_exp_f32 v218, v218
    v_smfmac_f32_32x32x32_bf16 v[224:239], v[104:107], v[208:215], v244
    v_sub_f32 v219, v219, v252
    v_exp_f32 v219, v219
    v_sub_f32 v220, v220, v252
    v_exp_f32 v220, v220
    v_sub_f32 v221, v221, v252
    v_exp_f32 v221, v221
    v_sub_f32 v222, v222, v252
    v_exp_f32 v222, v222
    v_sub_f32 v223, v223, v252
    v_exp_f32 v223, v223
    v_sub_f32 v192, v192, v252
    v_exp_f32 v192, v192
    v_sub_f32 v193, v193, v252
    v_exp_f32 v193, v193
    v_smfmac_f32_32x32x32_bf16 v[224:239], v[108:111], v[216:223], v244
    v_sub_f32 v194, v194, v252
    v_exp_f32 v194, v194
    v_sub_f32 v195, v195, v252
    v_exp_f32 v195, v195
    v_sub_f32 v196, v196, v252
    v_exp_f32 v196, v196
    v_mfma_f32_32x32x16_bf16 v[208:223], v[28:31], v[240:243], 0
    v_sub_f32 v197, v197, v252
    v_exp_f32 v197, v197
    v_sub_f32 v198, v198, v252
    v_exp_f32 v198, v198
    v_sub_f32 v199, v199, v252
    v_exp_f32 v199, v199
    v_sub_f32 v200, v200, v252
    v_exp_f32 v200, v200
    v_sub_f32 v201, v201, v252
    v_exp_f32 v201, v201
    v_sub_f32 v202, v202, v252
    v_exp_f32 v202, v202
    v_smfmac_f32_32x32x32_bf16 v[224:239], v[112:115], v[192:199], v244
    v_sub_f32 v203, v203, v252
    v_exp_f32 v203, v203
    v_sub_f32 v204, v204, v252
    v_exp_f32 v204, v204
    v_sub_f32 v205, v205, v252
    v_exp_f32 v205, v205
    v_sub_f32 v206, v206, v252
    v_exp_f32 v206, v206
    v_sub_f32 v207, v207, v252
    v_exp_f32 v207, v207
    v_sub_f32 v208, v208, v252
    v_exp_f32 v208, v208
    v_sub_f32 v209, v209, v252
    v_exp_f32 v209, v209
    v_smfmac_f32_32x32x32_bf16 v[224:239], v[116:119], v[200:207], v244
    v_sub_f32 v210, v210, v252
    v_exp_f32 v210, v210
    v_sub_f32 v211, v211, v252
    v_exp_f32 v211, v211
    v_sub_f32 v212, v212, v252
    v_exp_f32 v212, v212
    v_mfma_f32_32x32x16_bf16 v[192:207], v[32:35], v[240:243], 0
    v_sub_f32 v213, v213, v252
    v_exp_f32 v213, v213
    v_sub_f32 v214, v214, v252
    v_exp_f32 v214, v214
    v_sub_f32 v215, v215, v252
    v_exp_f32 v215, v215
    v_sub_f32 v216, v216, v252
    v_exp_f32 v216, v216
    v_sub_f32 v217, v217, v252
    v_exp_f32 v217, v217
    v_sub_f32 v218, v218, v252
    v_exp_f32 v218, v218
    v_smfmac_f32_32x32x32_bf16 v[224:239], v[120:123], v[208:215], v244
    v_sub_f32 v219, v219, v252
    v_exp_f32 v219, v219
    v_sub_f32 v220, v220, v252
    v_exp_f32 v220, v220
    v_sub_f32 v221, v221, v252
    v_exp_f32 v221, v221
    v_sub_f32 v222, v222, v252
    v_exp_f32 v222, v222
    v_sub_f32 v223, v223, v252
    v_exp_f32 v223, v223
    v_sub_f32 v192, v192, v252
    v_exp_f32 v192, v192
    v_sub_f32 v193, v193, v252
    v_exp_f32 v193, v193
    v_smfmac_f32_32x32x32_bf16 v[224:239], v[124:127], v[216:223], v244
    v_sub_f32 v194, v194, v252
    v_exp_f32 v194, v194
    v_sub_f32 v195, v195, v252
    v_exp_f32 v195, v195
    v_sub_f32 v196, v196, v252
    v_exp_f32 v196, v196
    v_mfma_f32_32x32x16_bf16 v[208:223], v[36:39], v[240:243], 0
    v_sub_f32 v197, v197, v252
    v_exp_f32 v197, v197
    v_sub_f32 v198, v198, v252
    v_exp_f32 v198, v198
    v_sub_f32 v199, v199, v252
    v_exp_f32 v199, v199
    v_sub_f32 v200, v200, v252
    v_exp_f32 v200, v200
    v_sub_f32 v201, v201, v252
    v_exp_f32 v201, v201
    v_sub_f32 v202, v202, v252
    v_exp_f32 v202, v202
    v_smfmac_f32_32x32x32_bf16 v[224:239], v[128:131], v[192:199], v244
    v_sub_f32 v203, v203, v252
    v_exp_f32 v203, v203
    v_sub_f32 v204, v204, v252
    v_exp_f32 v204, v204
    v_sub_f32 v205, v205, v252
    v_exp_f32 v205, v205
    v_sub_f32 v206, v206, v252
    v_exp_f32 v206, v206
    v_sub_f32 v207, v207, v252
    v_exp_f32 v207, v207
    v_sub_f32 v208, v208, v252
    v_exp_f32 v208, v208
    v_sub_f32 v209, v209, v252
    v_exp_f32 v209, v209
    v_smfmac_f32_32x32x32_bf16 v[224:239], v[132:135], v[200:207], v244
    v_sub_f32 v210, v210, v252
    v_exp_f32 v210, v210
    v_sub_f32 v211, v211, v252
    v_exp_f32 v211, v211
    v_sub_f32 v212, v212, v252
    v_exp_f32 v212, v212
    v_mfma_f32_32x32x16_bf16 v[192:207], v[40:43], v[240:243], 0
    v_sub_f32 v213, v213, v252
    v_exp_f32 v213, v213
    v_sub_f32 v214, v214, v252
    v_exp_f32 v214, v214
    v_sub_f32 v215, v215, v252
    v_exp_f32 v215, v215
    v_sub_f32 v216, v216, v252
    v_exp_f32 v216, v216
    v_sub_f32 v217, v217, v252
    v_exp_f32 v217, v217
    v_sub_f32 v218, v218, v252
    v_exp_f32 v218, v218
    v_smfmac_f32_32x32x32_bf16 v[224:239], v[136:139], v[208:215], v244
    v_sub_f32 v219, v219, v252
    v_exp_f32 v219, v219
    v_sub_f32 v220, v220, v252
    v_exp_f32 v220, v220
    v_sub_f32 v221, v221, v252
    v_exp_f32 v221, v221
    v_sub_f32 v222, v222, v252
    v_exp_f32 v222, v222
    v_sub_f32 v223, v223, v252
    v_exp_f32 v223, v223
    v_sub_f32 v192, v192, v252
    v_exp_f32 v192, v192
    v_sub_f32 v193, v193, v252
    v_exp_f32 v193, v193
    v_smfmac_f32_32x32x32_bf16 v[224:239], v[140:143], v[216:223], v244
    v_sub_f32 v194, v194, v252
    v_exp_f32 v194, v194
    v_sub_f32 v195, v195, v252
    v_exp_f32 v195, v195
    v_sub_f32 v196, v196, v252
    v_exp_f32 v196, v196
    v_mfma_f32_32x32x16_bf16 v[208:223], v[44:47], v[240:243], 0
    v_sub_f32 v197, v197, v252
    v_exp_f32 v197, v197
    v_sub_f32 v198, v198, v252
    v_exp_f32 v198, v198
    v_sub_f32 v199, v199, v252
    v_exp_f32 v199, v199
    v_sub_f32 v200, v200, v252
    v_exp_f32 v200, v200
    v_sub_f32 v201, v201, v252
    v_exp_f32 v201, v201
    v_sub_f32 v202, v202, v252
    v_exp_f32 v202, v202
    v_smfmac_f32_32x32x32_bf16 v[224:239], v[144:147], v[192:199], v244
    v_sub_f32 v203, v203, v252
    v_exp_f32 v203, v203
    v_sub_f32 v204, v204, v252
    v_exp_f32 v204, v204
    v_sub_f32 v205, v205, v252
    v_exp_f32 v205, v205
    v_sub_f32 v206, v206, v252
    v_exp_f32 v206, v206
    v_sub_f32 v207, v207, v252
    v_exp_f32 v207, v207
    v_sub_f32 v208, v208, v252
    v_exp_f32 v208, v208
    v_sub_f32 v209, v209, v252
    v_exp_f32 v209, v209
    v_smfmac_f32_32x32x32_bf16 v[224:239], v[148:151], v[200:207], v244
    v_sub_f32 v210, v210, v252
    v_exp_f32 v210, v210
    v_sub_f32 v211, v211, v252
    v_exp_f32 v211, v211
    v_sub_f32 v212, v212, v252
    v_exp_f32 v212, v212
    v_mfma_f32_32x32x16_bf16 v[192:207], v[48:51], v[240:243], 0
    v_sub_f32 v213, v213, v252
    v_exp_f32 v213, v213
    v_sub_f32 v214, v214, v252
    v_exp_f32 v214, v214
    v_sub_f32 v215, v215, v252
    v_exp_f32 v215, v215
    v_sub_f32 v216, v216, v252
    v_exp_f32 v216, v216
    v_sub_f32 v217, v217, v252
    v_exp_f32 v217, v217
    v_sub_f32 v218, v218, v252
    v_exp_f32 v218, v218
    v_smfmac_f32_32x32x32_bf16 v[224:239], v[152:155], v[208:215], v244
    v_sub_f32 v219, v219, v252
    v_exp_f32 v219, v219
    v_sub_f32 v220, v220, v252
    v_exp_f32 v220, v220
    v_sub_f32 v221, v221, v252
    v_exp_f32 v221, v221
    v_sub_f32 v222, v222, v252
    v_exp_f32 v222, v222
    v_sub_f32 v223, v223, v252
    v_exp_f32 v223, v223
    v_sub_f32 v192, v192, v252
    v_exp_f32 v192, v192
    v_sub_f32 v193, v193, v252
    v_exp_f32 v193, v193
    v_smfmac_f32_32x32x32_bf16 v[224:239], v[156:159], v[216:223], v244
    v_sub_f32 v194, v194, v252
    v_exp_f32 v194, v194
    v_sub_f32 v195, v195, v252
    v_exp_f32 v195, v195
    v_sub_f32 v196, v196, v252
    v_exp_f32 v196, v196
    v_mfma_f32_32x32x16_bf16 v[208:223], v[52:55], v[240:243], 0
    v_sub_f32 v197, v197, v252
    v_exp_f32 v197, v197
    v_sub_f32 v198, v198, v252
    v_exp_f32 v198, v198
    v_sub_f32 v199, v199, v252
    v_exp_f32 v199, v199
    v_sub_f32 v200, v200, v252
    v_exp_f32 v200, v200
    v_sub_f32 v201, v201, v252
    v_exp_f32 v201, v201
    v_sub_f32 v202, v202, v252
    v_exp_f32 v202, v202
    v_smfmac_f32_32x32x32_bf16 v[224:239], v[160:163], v[192:199], v244
    v_sub_f32 v203, v203, v252
    v_exp_f32 v203, v203
    v_sub_f32 v204, v204, v252
    v_exp_f32 v204, v204
    v_sub_f32 v205, v205, v252
    v_exp_f32 v205, v205
    v_sub_f32 v206, v206, v252
    v_exp_f32 v206, v206
    v_sub_f32 v207, v207, v252
    v_exp_f32 v207, v207
    v_sub_f32 v208, v208, v252
    v_exp_f32 v208, v208
    v_sub_f32 v209, v209, v252
    v_exp_f32 v209, v209
    v_smfmac_f32_32x32x32_bf16 v[224:239], v[164:167], v[200:207], v244
    v_sub_f32 v210, v210, v252
    v_exp_f32 v210, v210
    v_sub_f32 v211, v211, v252
    v_exp_f32 v211, v211
    v_sub_f32 v212, v212, v252
    v_exp_f32 v212, v212
    v_mfma_f32_32x32x16_bf16 v[192:207], v[56:59], v[240:243], 0
    v_sub_f32 v213, v213, v252
    v_exp_f32 v213, v213
    v_sub_f32 v214, v214, v252
    v_exp_f32 v214, v214
    v_sub_f32 v215, v215, v252
    v_exp_f32 v215, v215
    v_sub_f32 v216, v216, v252
    v_exp_f32 v216, v216
    v_sub_f32 v217, v217, v252
    v_exp_f32 v217, v217
    v_sub_f32 v218, v218, v252
    v_exp_f32 v218, v218
    v_smfmac_f32_32x32x32_bf16 v[224:239], v[168:171], v[208:215], v244
    v_sub_f32 v219, v219, v252
    v_exp_f32 v219, v219
    v_sub_f32 v220, v220, v252
    v_exp_f32 v220, v220
    v_sub_f32 v221, v221, v252
    v_exp_f32 v221, v221
    v_sub_f32 v222, v222, v252
    v_exp_f32 v222, v222
    v_sub_f32 v223, v223, v252
    v_exp_f32 v223, v223
    v_sub_f32 v192, v192, v252
    v_exp_f32 v192, v192
    v_sub_f32 v193, v193, v252
    v_exp_f32 v193, v193
    v_smfmac_f32_32x32x32_bf16 v[224:239], v[172:175], v[216:223], v244
    v_sub_f32 v194, v194, v252
    v_exp_f32 v194, v194
    v_sub_f32 v195, v195, v252
    v_exp_f32 v195, v195
    v_sub_f32 v196, v196, v252
    v_exp_f32 v196, v196
    v_mfma_f32_32x32x16_bf16 v[208:223], v[60:63], v[240:243], 0
    s_add_u32 s10, s73, 1
    s_lshr_b32 s11, s10, 1
    s_sub_u32 s11, s72, s11
    v_sub_f32 v197, v197, v252
    v_exp_f32 v197, v197
    s_and_b32 s11, s11, 3
    s_and_b32 s10, s10, 1
    s_lshl_b32 s10, s10, 2
    v_sub_f32 v198, v198, v252
    v_exp_f32 v198, v198
    s_add_u32 s11, s11, s10
    s_lshl_b32 s9, s11, 10
    v_sub_f32 v199, v199, v252
    v_exp_f32 v199, v199
    v_add_u32 v247, s9, v251
    v_sub_f32 v200, v200, v252
    v_exp_f32 v200, v200
    ds_read_b128 v[240:243], v247 offset:5120
    v_sub_f32 v201, v201, v252
    v_exp_f32 v201, v201
    v_sub_f32 v202, v202, v252
    v_exp_f32 v202, v202
    v_smfmac_f32_32x32x32_bf16 v[224:239], v[176:179], v[192:199], v244
    v_sub_f32 v203, v203, v252
    v_exp_f32 v203, v203
    v_sub_f32 v204, v204, v252
    v_exp_f32 v204, v204
    v_sub_f32 v205, v205, v252
    v_exp_f32 v205, v205
    v_sub_f32 v206, v206, v252
    v_exp_f32 v206, v206
    v_sub_f32 v207, v207, v252
    v_exp_f32 v207, v207
    v_sub_f32 v208, v208, v252
    v_exp_f32 v208, v208
    v_sub_f32 v209, v209, v252
    v_exp_f32 v209, v209
    v_smfmac_f32_32x32x32_bf16 v[224:239], v[180:183], v[200:207], v244
    v_sub_f32 v210, v210, v252
    v_exp_f32 v210, v210
    v_sub_f32 v211, v211, v252
    v_exp_f32 v211, v211
    v_sub_f32 v212, v212, v252
    v_exp_f32 v212, v212
    s_waitcnt lgkmcnt(0)
    v_mfma_f32_32x32x16_bf16 v[192:207], v[0:3], v[240:243], 0
    v_sub_f32 v213, v213, v252
    v_exp_f32 v213, v213
    v_sub_f32 v214, v214, v252
    v_exp_f32 v214, v214
    v_sub_f32 v215, v215, v252
    v_exp_f32 v215, v215
    v_sub_f32 v216, v216, v252
    v_exp_f32 v216, v216
    v_sub_f32 v217, v217, v252
    v_exp_f32 v217, v217
    v_sub_f32 v218, v218, v252
    v_exp_f32 v218, v218
    v_smfmac_f32_32x32x32_bf16 v[224:239], v[184:187], v[208:215], v244
    v_sub_f32 v219, v219, v252
    v_exp_f32 v219, v219
    v_sub_f32 v220, v220, v252
    v_exp_f32 v220, v220
    v_sub_f32 v221, v221, v252
    v_exp_f32 v221, v221
    v_sub_f32 v222, v222, v252
    v_exp_f32 v222, v222
    v_sub_f32 v223, v223, v252
    v_exp_f32 v223, v223
    s_cmp_lt_u32 s73, 23
    s_cbranch_scc1 L_loop_s
    v_smfmac_f32_32x32x32_bf16 v[224:239], v[188:191], v[216:223], v244
    s_nop 10
    s_branch L_end_s
L_finx_s:
    v_sub_f32 v200, v200, v252
    v_exp_f32 v200, v200
    v_sub_f32 v201, v201, v252
    v_exp_f32 v201, v201
    v_rcp_f32 v232, v232
    s_add_u32 s9, s75, 0
    v_pk_mul_f32 v[224:225], v[232:233], v[224:225] op_sel:[0,0] op_sel_hi:[0,1]
    v_pk_mul_f32 v[226:227], v[232:233], v[226:227] op_sel:[0,0] op_sel_hi:[0,1]
    v_pk_mul_f32 v[228:229], v[232:233], v[228:229] op_sel:[0,0] op_sel_hi:[0,1]
    v_pk_mul_f32 v[230:231], v[232:233], v[230:231] op_sel:[0,0] op_sel_hi:[0,1]
    v_cvt_pk_bf16_f32 v224, v224, v225
    v_cvt_pk_bf16_f32 v225, v226, v227
    v_cvt_pk_bf16_f32 v226, v228, v229
    v_cvt_pk_bf16_f32 v227, v230, v231
    buffer_store_dwordx4 v[224:227], v251, s[64:67], s9 offen sc1
    s_branch L_finxd_s
L_hw_s:
    s_mov_b32 s15, 400000
L_hl_s:
    s_sleep 1
    ds_read_b64 v[232:233], v246 offset:1024
    ds_read_b128 v[224:227], v245 offset:13312
    ds_read_b128 v[228:231], v245 offset:14336
    s_waitcnt lgkmcnt(0)
    v_cmp_gt_u32 vcc, s73, v233
    s_nop 0
    s_cbranch_vccz L_hd_s
    s_sub_u32 s15, s15, 1
    s_cbranch_scc0 L_hl_s
    s_branch L_hd_s
L_end_s:
    s_branch L_attn_epi
L_exit:
    s_endpgm
.section .rodata,"a"
.p2align 6
.amdhsa_kernel concat_heads__grouped_kv_mqa__ssm_conv_s5__prompt_kernel
  .amdhsa_next_free_vgpr 256
  .amdhsa_next_free_sgpr 102
  .amdhsa_accum_offset 256
  .amdhsa_group_segment_fixed_size 0
  .amdhsa_kernarg_size 136
  .amdhsa_user_sgpr_count 2
  .amdhsa_user_sgpr_kernarg_segment_ptr 1
  .amdhsa_system_sgpr_workgroup_id_x 1
.end_amdhsa_kernel
```
